```python
import torch

def _softmax(x, axis=-1):
    return torch.softmax(x, dim=axis)
def _gelu(x):
    return torch.nn.functional.gelu(x, approximate="tanh")
def _silu(x):
    return torch.nn.functional.silu(x)
def _sigmoid(x):
    return torch.sigmoid(x)
def _layernorm(x, axis=-1, eps=1e-5):
    m = x.mean(dim=axis, keepdim=True)
    v = x.var(dim=axis, keepdim=True, unbiased=False)
    return (x - m) / torch.sqrt(v + eps)
def _scatter_add(tgt, idx, src, axis=0):
    return tgt.clone().index_add_(axis, idx, src)
def _segment_sum(src, seg, n):
    out = torch.zeros((n,) + src.shape[1:], dtype=src.dtype)
    return out.index_add_(0, seg, src)
def _pad(x, pw):
    flat = tuple(v for pair in reversed(pw) for v in pair)
    return torch.nn.functional.pad(x, flat)

kernel_name = 'gated_mix__spectral_fnet__linear_kernel_hedgehog__prompt'

def setup_inputs():

    _w = (lambda a: (lambda t: t.to(torch.bfloat16) if t.is_floating_point() else t)(torch.as_tensor(a)))
    def _A_setup():
        B, S, D = 1, 2048, 448
        ns = torch.arange(S)[:, None] * torch.arange(S)[None, :]
        nd = torch.arange(D)[:, None] * torch.arange(D)[None, :]
        Ws_re = torch.cos(-2.0 * torch.pi * ns / S).to(float)
        Ws_im = torch.sin(-2.0 * torch.pi * ns / S).to(float)
        Wd_re = torch.cos(-2.0 * torch.pi * nd / D).to(float)
        Wd_im = torch.sin(-2.0 * torch.pi * nd / D).to(float)
        return {
            "x": _w((lambda *s: torch.randn(*s, dtype=torch.bfloat16) * 0.1)(B, S, D)),
            "dft_seq_re": _w(Ws_re),
            "dft_seq_im": _w(Ws_im),
            "dft_hid_re": _w(Wd_re),
            "dft_hid_im": _w(Wd_im),
        }
    _A_in = _A_setup()

    def _B_setup():
        B, S, D, H = 1, 2048, 448, 16
        Dh = D // H
        return {
            "x": _w((lambda *s: torch.randn(*s, dtype=torch.bfloat16) * 0.1)(B, S, D)),
            "wqkv": _w((lambda *s: torch.randn(*s, dtype=torch.bfloat16) * 1.6)(D, 3 * D)),
            "w_phi": _w((lambda *s: torch.randn(*s, dtype=torch.bfloat16) * 1.6)(H, Dh, Dh) * (Dh ** -0.5)),
            "wo": _w((lambda *s: torch.randn(*s, dtype=torch.bfloat16) * 1.6)(D, D)),
        }
    _B_in = _B_setup()

    return {
        "A_x": _A_in["x"],
        "A_dft_seq_re": _A_in["dft_seq_re"],
        "A_dft_seq_im": _A_in["dft_seq_im"],
        "A_dft_hid_re": _A_in["dft_hid_re"],
        "A_dft_hid_im": _A_in["dft_hid_im"],
        "B_x": _B_in["x"],
        "B_wqkv": _B_in["wqkv"],
        "B_w_phi": _B_in["w_phi"],
        "B_wo": _B_in["wo"],
        "gate_w": _w((lambda *s: torch.randn(*s, dtype=torch.bfloat16) * 0.1)(448) * 16.0),
    }

def reference(A_x, A_dft_seq_re, A_dft_seq_im, A_dft_hid_re, A_dft_hid_im, B_x, B_wqkv, B_w_phi, B_wo, gate_w):
    def _A_ref(x, dft_seq_re, dft_seq_im, dft_hid_re, dft_hid_im):
        a = torch.einsum("bsd,ed->bse", x, dft_hid_re)
        b = torch.einsum("bsd,ed->bse", x, dft_hid_im)
        y = torch.einsum("ts,bse->bte", dft_seq_re, a) - torch.einsum("ts,bse->bte", dft_seq_im, b)
        return y

    def _B_ref(x, wqkv, w_phi, wo):
        B, S, D = x.shape
        H = 16; Dh = D // H
        qkv = (lambda x, *d: x.permute(*d))((x @ wqkv).reshape(B, S, 3, H, Dh), 2, 0, 3, 1, 4)
        q, k, v = qkv[0], qkv[1], qkv[2]
        pq = torch.einsum("bhsd,hdf->bhsf", q, w_phi)
        pk = torch.einsum("bhsd,hdf->bhsf", k, w_phi)
        phi_q = torch.concatenate([_softmax(pq, axis=-1), _softmax(-pq, axis=-1)], axis=-1)
        phi_k = torch.concatenate([_softmax(pk, axis=-1), _softmax(-pk, axis=-1)], axis=-1)
        kv = torch.einsum("bhsf,bhsd->bhfd", phi_k, v)
        z  = torch.einsum("bhsf->bhf", phi_k)
        num = torch.einsum("bhqf,bhfd->bhqd", phi_q, kv)
        den = torch.einsum("bhqf,bhf->bhq", phi_q, z)[..., None] + 1e-6
        o = num / den
        return (lambda x, *d: x.permute(*d))(o, 0, 2, 1, 3).reshape(B, S, D) @ wo

    x = A_x
    g = _sigmoid((x * gate_w).sum(-1, keepdims=True))
    a = _A_ref(x, A_dft_seq_re, A_dft_seq_im, A_dft_hid_re, A_dft_hid_im)
    b = _B_ref(x, B_wqkv, B_w_phi, B_wo)
    return g * a + (1 - g) * b
```

```asm
; @launch grid=(256,1,1) block=(512,1,1) lds=163840
.amdgcn_target "amdgcn-amd-amdhsa--gfx950"
.text
.globl gated_mix__spectral_fnet__linear_kernel_hedgehog__prompt_kernel
.p2align 8
.type gated_mix__spectral_fnet__linear_kernel_hedgehog__prompt_kernel,@function
gated_mix__spectral_fnet__linear_kernel_hedgehog__prompt_kernel:
    s_cmp_ge_u32 s2, 256
    s_cbranch_scc1 K_END
    s_load_dwordx2 s[16:17], s[0:1], 48
    s_load_dwordx2 s[12:13], s[0:1], 0
    s_load_dwordx2 s[20:21], s[0:1], 56
    s_load_dwordx2 s[28:29], s[0:1], 72
    s_load_dwordx2 s[32:33], s[0:1], 96
    s_load_dwordx2 s[24:25], s[0:1], 64
    s_load_dwordx2 s[40:41], s[0:1], 80
    v_lshrrev_b32 v4, 6, v0
    v_and_b32 v1, 63, v0
    s_and_b32 s60, s2, 7
    v_readfirstlane_b32 s3, v4
    s_lshr_b32 s61, s2, 3
    v_mad_u32_u24 v5, v4, 1, v1
    s_and_b32 s66, s61, 31
    s_mul_i32 s66, s66, 8
    v_add_u32 v5, s66, v5
    v_lshlrev_b32 v5, 7, v5
    s_getpc_b64 s[64:65]
CPF_HERE:
    s_sub_u32 s64, s64, CPF_HERE-gated_mix__spectral_fnet__linear_kernel_hedgehog__prompt_kernel
    s_subb_u32 s65, s65, 0
    v_min_u32 v5, K_LAST-gated_mix__spectral_fnet__linear_kernel_hedgehog__prompt_kernel, v5
    v_mov_b32 v7, s65
    v_add_co_u32 v6, vcc, s64, v5
    s_nop 1
    v_addc_co_u32 v7, vcc, 0, v7, vcc
    s_mov_b64 exec, 1
    global_load_dword v255, v[6:7], off
    s_mov_b64 exec, -1
    s_and_b32 s62, s61, 3
    s_lshr_b32 s10, s61, 2
    s_lshl_b32 s9, s60, 2
    s_add_u32 s9, s9, s62
    s_and_b32 s4, s9, 15
    s_lshr_b32 s5, s60, 2
    s_lshl_b32 s5, s5, 3
    s_add_u32 s5, s5, s10
    s_xor_b32 s6, s5, 1
    s_and_b32 s8, s3, 3
    s_lshl_b32 s7, s4, 2
    s_add_u32 s7, s7, s8
    s_lshl_b32 s62, s4, 1
    s_add_u32 s62, s62, s5
    s_mul_i32 s63, s62, 37
    s_lshr_b32 s63, s63, 8
    s_mul_i32 s63, s63, 7
    s_sub_u32 s11, s62, s63
    s_mov_b32 s62, s11
    s_lshl_b32 s44, s62, 7
    s_mul_i32 s51, s62, 172032
    s_add_u32 s62, s62, 1
    s_cmp_eq_u32 s62, 7
    s_cselect_b32 s62, 0, s62
    s_lshl_b32 s45, s62, 7
    s_mul_i32 s52, s62, 172032
    s_mov_b32 s14, 1835008
    s_mov_b32 s15, 0x20000
    s_mov_b32 s18, 1204224
    s_mov_b32 s19, 0x20000
    v_lshrrev_b32 v6, 3, v1
    v_and_b32 v7, 7, v1
    v_lshrrev_b32 v8, 4, v1
    v_xor_b32 v7, v7, v8
    v_lshlrev_b32 v7, 4, v7
    s_mov_b32 s63, 57344
    v_mad_u32_u24 v11, v6, s63, v7
    s_lshr_b32 s64, s3, 2
    s_lshl_b32 s58, s8, 12
    s_lshl_b32 s60, s64, 11
    s_add_u32 s58, s58, s60
    s_mul_i32 s60, s7, 896
    s_mul_i32 s61, s64, 917504
    s_add_u32 s60, s60, s61
    v_add_u32 v11, s60, v11
    v_xor_b32 v12, 64, v11
    v_add_u32 v12, 457728, v12
    s_cmp_ge_u32 s3, 4
    s_cbranch_scc1 B_START
    s_setprio 2
    v_lshrrev_b32 v4, 2, v1
    v_and_b32 v5, 3, v1
    v_lshlrev_b32 v5, 4, v5
    v_min_u32 v5, 40, v5
    s_movk_i32 s63, 2688
    v_mad_u32_u24 v10, v4, s63, v5
    s_mul_i32 s60, s8, 43008
    s_mul_i32 s61, s5, 56
    s_add_u32 s60, s60, s61
    s_add_u32 s60, s60, 896
    v_add_u32 v10, s60, v10
    s_lshl_b32 s59, s8, 10
    v_add_u32 v28, 917504, v11
    v_add_u32 v29, 917504, v12
    v_lshlrev_b32 v3, 4, v1
    s_lshl_b32 s64, s5, 2
    s_add_u32 s64, s64, s8
    s_lshl_b32 s64, s64, 4
    s_add_u32 s64, s64, s4
    s_lshl_b32 s64, s64, 10
    s_add_u32 s64, s64, 4194304
    s_mov_b32 s34, 7340032
    s_mov_b32 s35, 0x20000
    s_mov_b32 s37, 5246976
    s_waitcnt lgkmcnt(0)
    s_add_u32 m0, s59, 81920
    s_nop 0
    buffer_load_dwordx4 v10, s[16:19], s51 offen lds
    s_add_u32 m0, s58, 0
    s_nop 0
    buffer_load_dwordx4 v11, s[12:15], s44 offen lds
    buffer_load_dwordx4 v12, s[12:15], s44 offen offset:1024 lds
    s_add_u32 m0, s58, 16384
    s_nop 0
    buffer_load_dwordx4 v11, s[12:15], s45 offen lds
    buffer_load_dwordx4 v12, s[12:15], s45 offen offset:1024 lds
    s_add_u32 m0, s58, 18432
    s_nop 0
    buffer_load_dwordx4 v28, s[12:15], s45 offen lds
    buffer_load_dwordx4 v29, s[12:15], s45 offen offset:1024 lds
    s_load_dword s36, s[32:33], s37
    s_add_u32 s62, s62, 1
    s_cmp_eq_u32 s62, 7
    s_cselect_b32 s62, 0, s62
    s_lshl_b32 s46, s62, 7
    s_mul_i32 s53, s62, 172032
    s_add_u32 s62, s62, 1
    s_cmp_eq_u32 s62, 7
    s_cselect_b32 s62, 0, s62
    s_lshl_b32 s47, s62, 7
    s_mul_i32 s54, s62, 172032
    s_add_u32 s62, s62, 1
    s_cmp_eq_u32 s62, 7
    s_cselect_b32 s62, 0, s62
    s_lshl_b32 s48, s62, 7
    s_mul_i32 s55, s62, 172032
    s_add_u32 s62, s62, 1
    s_cmp_eq_u32 s62, 7
    s_cselect_b32 s62, 0, s62
    s_lshl_b32 s49, s62, 7
    s_mul_i32 s56, s62, 172032
    s_add_u32 s62, s62, 1
    s_cmp_eq_u32 s62, 7
    s_cselect_b32 s62, 0, s62
    s_lshl_b32 s50, s62, 7
    s_mul_i32 s57, s62, 172032
    s_mov_b32 s22, 25088
    s_mov_b32 s23, 0x20000
    s_mov_b32 s26, 401408
    s_mov_b32 s27, 0x20000
    s_mov_b32 s34, 7340032
    s_mov_b32 s35, 0x20000
    s_mov_b32 s42, 1835008
    s_mov_b32 s43, 0x20000
    v_lshlrev_b32 v3, 4, v1
    v_and_b32 v6, 31, v1
    v_lshrrev_b32 v7, 5, v1
    v_bfe_u32 v8, v1, 1, 3
    v_xor_b32 v8, v8, v7
    v_lshlrev_b32 v8, 4, v8
    v_lshl_add_u32 v16, v6, 7, v8
    s_lshl_b32 s60, s8, 12
    v_add_u32 v16, s60, v16
    v_xor_b32 v17, 32, v16
    v_xor_b32 v18, 64, v16
    v_xor_b32 v19, 0x60, v16
    v_bfe_u32 v8, v1, 4, 1
    v_and_b32 v9, 3, v1
    v_lshl_add_u32 v8, v8, 2, v9
    v_cmp_lt_u32 vcc, 5, v8
    s_nop 1
    v_cndmask_b32 v8, v8, 7, vcc
    v_lshlrev_b32 v8, 3, v8
    v_bfe_u32 v9, v1, 2, 2
    v_lshl_add_u32 v8, v9, 6, v8
    v_lshl_add_u32 v20, v7, 9, v8
    s_mov_b32 s68, 1069066811
    s_mov_b32 s69, 3216550459
    s_and_b32 s60, s8, 1
    s_lshl_b32 s60, s60, 4
    v_add_u32 v9, s60, v4
    s_cmp_lt_u32 s8, 2
    s_cselect_b32 s61, s5, s6
    s_mul_i32 s61, s61, 1568
    v_mad_u32_u24 v13, v9, 56, v5
    v_add_u32 v13, s61, v13
    v_cmp_lt_u32 vcc, 27, v9
    v_bfrev_b32 v9, 1
    s_nop 0
    v_cndmask_b32 v13, v13, v9, vcc
    v_lshl_add_u32 v22, v7, 8, v8
    v_add_u32 v22, 139264, v22
    v_add_u32 v21, 49152, v20
    v_add_u32 v20, 81920, v20
    v_add_u32 v15, 896, v10
    s_sub_u32 s60, s6, s5
    s_mul_i32 s60, s60, 56
    s_sub_u32 s60, s60, 896
    v_add_u32 v14, s60, v10
    v_add_u32 v247, s64, v3
    v_and_b32 v9, 15, v1
    v_lshlrev_b32 v9, 4, v9
    v_lshl_add_u32 v9, v7, 8, v9
    v_lshrrev_b32 v4, 4, v6
    v_lshl_add_u32 v9, v4, 14, v9
    s_lshl_b32 s60, s7, 15
    s_lshl_b32 s61, s6, 10
    s_add_u32 s60, s60, s61
    v_add_u32 v2, s60, v9
    v_and_b32 v4, 7, v1
    v_xor_b32 v4, v4, v7
    v_lshlrev_b32 v4, 4, v4
    v_lshl_add_u32 v4, v6, 7, v4
    s_lshl_b32 s60, s8, 12
    v_add_u32 v240, s60, v4
    v_xor_b32 v241, 32, v240
    v_xor_b32 v242, 64, v240
    v_xor_b32 v243, 0x60, v240
    v_lshrrev_b32 v4, 2, v1
    v_and_b32 v5, 7, v4
    v_bfe_u32 v9, v1, 1, 1
    s_lshl_b32 s60, s8, 1
    v_or_b32 v9, s60, v9
    v_xor_b32 v9, v9, v5
    v_lshlrev_b32 v9, 4, v9
    v_lshl_add_u32 v9, v4, 7, v9
    v_and_b32 v8, 1, v1
    v_lshl_add_u32 v244, v8, 3, v9
    v_lshrrev_b32 v5, 1, v5
    v_xor_b32 v5, v5, v8
    v_lshlrev_b32 v5, 4, v5
    v_lshl_add_u32 v5, v4, 6, v5
    v_bfe_u32 v9, v1, 1, 1
    v_lshl_add_u32 v5, v9, 3, v5
    v_add_u32 v245, 16384, v5
    v_xor_b32 v246, 32, v245
    v_add_u32 v24, 0x10000, v16
    v_add_u32 v25, 0x10000, v17
    v_add_u32 v26, 0x10000, v18
    v_add_u32 v27, 0x10000, v19
    s_waitcnt vmcnt(4)
    s_add_u32 m0, s59, 86016
    s_nop 0
    buffer_load_dwordx4 v10, s[16:19], s52 offen lds
    s_add_u32 m0, s59, 139264
    s_nop 0
    buffer_load_dwordx4 v13, s[20:23], 0 offen lds
    s_add_u32 m0, s59, 90112
    s_nop 0
    buffer_load_dwordx4 v10, s[16:19], s53 offen lds
    s_add_u32 m0, s58, 32768
    s_nop 0
    buffer_load_dwordx4 v11, s[12:15], s46 offen lds
    buffer_load_dwordx4 v12, s[12:15], s46 offen offset:1024 lds
    s_add_u32 m0, s58, 34816
    s_nop 0
    buffer_load_dwordx4 v28, s[12:15], s46 offen lds
    buffer_load_dwordx4 v29, s[12:15], s46 offen offset:1024 lds
    s_barrier
    ds_read_b128 v[128:131], v16 offset:0
    ds_read_b64_tr_b16 v[32:33], v20 offset:0
    ds_read_b64_tr_b16 v[34:35], v20 offset:256
    ds_read_b128 v[132:135], v17 offset:0
    ds_read_b64_tr_b16 v[36:37], v20 offset:1024
    ds_read_b64_tr_b16 v[38:39], v20 offset:1280
    ds_read_b128 v[136:139], v18 offset:0
    ds_read_b64_tr_b16 v[40:41], v20 offset:2048
    ds_read_b64_tr_b16 v[42:43], v20 offset:2304
    ds_read_b128 v[140:143], v19 offset:0
    ds_read_b64_tr_b16 v[44:45], v20 offset:3072
    ds_read_b64_tr_b16 v[46:47], v20 offset:3328
    s_add_u32 m0, s59, 94208
    s_nop 0
    buffer_load_dwordx4 v10, s[16:19], s54 offen lds
    s_add_u32 m0, s58, 49152
    s_nop 0
    buffer_load_dwordx4 v11, s[12:15], s47 offen lds
    buffer_load_dwordx4 v12, s[12:15], s47 offen offset:1024 lds
    s_waitcnt vmcnt(9)
    s_barrier
    s_waitcnt lgkmcnt(9)
    v_mfma_f32_32x32x16_bf16 v[64:79], v[32:35], v[128:131], 0
    ds_read_b128 v[144:147], v16 offset:16384
    ds_read_b64_tr_b16 v[48:49], v20 offset:4096
    ds_read_b64_tr_b16 v[50:51], v20 offset:4352
    s_waitcnt lgkmcnt(9)
    v_mfma_f32_32x32x16_bf16 v[64:79], v[36:39], v[132:135], v[64:79]
    ds_read_b128 v[148:151], v17 offset:16384
    ds_read_b64_tr_b16 v[52:53], v20 offset:5120
    ds_read_b64_tr_b16 v[54:55], v20 offset:5376
    s_add_u32 m0, s59, 98304
    s_nop 0
    buffer_load_dwordx4 v10, s[16:19], s55 offen lds
    s_waitcnt lgkmcnt(9)
    v_mfma_f32_32x32x16_bf16 v[64:79], v[40:43], v[136:139], v[64:79]
    ds_read_b128 v[152:155], v18 offset:16384
    ds_read_b64_tr_b16 v[56:57], v20 offset:6144
    ds_read_b64_tr_b16 v[58:59], v20 offset:6400
    s_add_u32 m0, s58, 65536
    s_nop 0
    buffer_load_dwordx4 v11, s[12:15], s48 offen lds
    s_waitcnt lgkmcnt(9)
    v_mfma_f32_32x32x16_bf16 v[64:79], v[44:47], v[140:143], v[64:79]
    ds_read_b128 v[156:159], v19 offset:16384
    ds_read_b64_tr_b16 v[60:61], v20 offset:7168
    ds_read_b64_tr_b16 v[62:63], v20 offset:7424
    buffer_load_dwordx4 v12, s[12:15], s48 offen offset:1024 lds
    s_waitcnt vmcnt(6)
    s_barrier
    s_waitcnt lgkmcnt(9)
    v_mfma_f32_32x32x16_bf16 v[64:79], v[48:51], v[144:147], v[64:79]
    ds_read_b128 v[160:163], v16 offset:32768
    ds_read_b64_tr_b16 v[32:33], v20 offset:8192
    ds_read_b64_tr_b16 v[34:35], v20 offset:8448
    ds_read_b64_tr_b16 v[248:249], v22 offset:0
    ds_read_b64_tr_b16 v[250:251], v22 offset:512
    ds_read_b64_tr_b16 v[252:253], v22 offset:1024
    ds_read_b64_tr_b16 v[254:255], v22 offset:1536
    s_waitcnt lgkmcnt(13)
    v_mfma_f32_32x32x16_bf16 v[64:79], v[52:55], v[148:151], v[64:79]
    ds_read_b128 v[164:167], v17 offset:32768
    ds_read_b64_tr_b16 v[36:37], v20 offset:9216
    ds_read_b64_tr_b16 v[38:39], v20 offset:9472
    s_add_u32 m0, s59, 102400
    s_nop 0
    buffer_load_dwordx4 v10, s[16:19], s56 offen lds
    s_waitcnt lgkmcnt(13)
    v_mfma_f32_32x32x16_bf16 v[64:79], v[56:59], v[152:155], v[64:79]
    ds_read_b128 v[168:171], v18 offset:32768
    ds_read_b64_tr_b16 v[40:41], v20 offset:10240
    ds_read_b64_tr_b16 v[42:43], v20 offset:10496
    s_add_u32 m0, s58, 0
    s_nop 0
    buffer_load_dwordx4 v11, s[12:15], s49 offen lds
    s_waitcnt lgkmcnt(13)
    v_mfma_f32_32x32x16_bf16 v[64:79], v[60:63], v[156:159], v[64:79]
    ds_read_b128 v[172:175], v19 offset:32768
    ds_read_b64_tr_b16 v[44:45], v20 offset:11264
    ds_read_b64_tr_b16 v[46:47], v20 offset:11520
    buffer_load_dwordx4 v12, s[12:15], s49 offen offset:1024 lds
    s_waitcnt vmcnt(6)
    s_barrier
    s_waitcnt lgkmcnt(13)
    v_mfma_f32_32x32x16_bf16 v[64:79], v[32:35], v[160:163], v[64:79]
    ds_read_b128 v[176:179], v16 offset:49152
    ds_read_b64_tr_b16 v[48:49], v20 offset:12288
    ds_read_b64_tr_b16 v[50:51], v20 offset:12544
    s_waitcnt lgkmcnt(9)
    v_mfma_f32_32x32x16_bf16 v[64:79], v[36:39], v[164:167], v[64:79]
    ds_read_b128 v[180:183], v17 offset:49152
    ds_read_b64_tr_b16 v[52:53], v20 offset:13312
    ds_read_b64_tr_b16 v[54:55], v20 offset:13568
    s_add_u32 m0, s59, 106496
    s_nop 0
    buffer_load_dwordx4 v10, s[16:19], s57 offen lds
    s_waitcnt lgkmcnt(9)
    v_mfma_f32_32x32x16_bf16 v[64:79], v[40:43], v[168:171], v[64:79]
    ds_read_b128 v[184:187], v18 offset:49152
    ds_read_b64_tr_b16 v[56:57], v20 offset:14336
    ds_read_b64_tr_b16 v[58:59], v20 offset:14592
    s_add_u32 m0, s58, 16384
    s_nop 0
    buffer_load_dwordx4 v11, s[12:15], s50 offen lds
    s_waitcnt lgkmcnt(9)
    v_mfma_f32_32x32x16_bf16 v[64:79], v[44:47], v[172:175], v[64:79]
    ds_read_b128 v[188:191], v19 offset:49152
    ds_read_b64_tr_b16 v[60:61], v20 offset:15360
    ds_read_b64_tr_b16 v[62:63], v20 offset:15616
    buffer_load_dwordx4 v12, s[12:15], s50 offen offset:1024 lds
    s_waitcnt vmcnt(6)
    s_barrier
    s_waitcnt lgkmcnt(9)
    v_mfma_f32_32x32x16_bf16 v[64:79], v[48:51], v[176:179], v[64:79]
    ds_read_b128 v[192:195], v24
    ds_read_b64_tr_b16 v[32:33], v20 offset:16384
    ds_read_b64_tr_b16 v[34:35], v20 offset:16640
    s_waitcnt lgkmcnt(9)
    v_mfma_f32_32x32x16_bf16 v[64:79], v[52:55], v[180:183], v[64:79]
    ds_read_b128 v[196:199], v25
    ds_read_b64_tr_b16 v[36:37], v20 offset:17408
    ds_read_b64_tr_b16 v[38:39], v20 offset:17664
    s_add_u32 m0, s59, 143360
    s_nop 0
    buffer_load_dwordx4 v15, s[16:19], s51 offen lds
    s_waitcnt lgkmcnt(9)
    v_mfma_f32_32x32x16_bf16 v[64:79], v[56:59], v[184:187], v[64:79]
    ds_read_b128 v[200:203], v26
    ds_read_b64_tr_b16 v[40:41], v20 offset:18432
    ds_read_b64_tr_b16 v[42:43], v20 offset:18688
    s_waitcnt lgkmcnt(9)
    v_mfma_f32_32x32x16_bf16 v[64:79], v[60:63], v[188:191], v[64:79]
    ds_read_b128 v[204:207], v27
    ds_read_b64_tr_b16 v[44:45], v20 offset:19456
    ds_read_b64_tr_b16 v[46:47], v20 offset:19712
    s_add_u32 m0, s59, 147456
    s_nop 0
    buffer_load_dwordx4 v15, s[16:19], s52 offen lds
    s_waitcnt vmcnt(5)
    s_barrier
    s_waitcnt lgkmcnt(9)
    v_mfma_f32_32x32x16_bf16 v[64:79], v[32:35], v[192:195], v[64:79]
    ds_read_b128 v[208:211], v16 offset:0
    ds_read_b64_tr_b16 v[48:49], v20 offset:20480
    ds_read_b64_tr_b16 v[50:51], v20 offset:20736
    s_waitcnt lgkmcnt(9)
    v_mfma_f32_32x32x16_bf16 v[64:79], v[36:39], v[196:199], v[64:79]
    ds_read_b128 v[212:215], v17 offset:0
    ds_read_b64_tr_b16 v[52:53], v20 offset:21504
    ds_read_b64_tr_b16 v[54:55], v20 offset:21760
    s_waitcnt lgkmcnt(9)
    v_mfma_f32_32x32x16_bf16 v[64:79], v[40:43], v[200:203], v[64:79]
    ds_read_b128 v[216:219], v18 offset:0
    ds_read_b64_tr_b16 v[56:57], v20 offset:22528
    ds_read_b64_tr_b16 v[58:59], v20 offset:22784
    s_waitcnt lgkmcnt(9)
    v_mfma_f32_32x32x16_bf16 v[64:79], v[44:47], v[204:207], v[64:79]
    ds_read_b128 v[220:223], v19 offset:0
    ds_read_b64_tr_b16 v[60:61], v20 offset:23552
    ds_read_b64_tr_b16 v[62:63], v20 offset:23808
    s_add_u32 m0, s59, 159744
    s_nop 0
    buffer_load_dwordx4 v15, s[16:19], s55 offen lds
    s_waitcnt vmcnt(3)
    s_barrier
    s_waitcnt lgkmcnt(9)
    v_mfma_f32_32x32x16_bf16 v[64:79], v[48:51], v[208:211], v[64:79]
    ds_read_b128 v[224:227], v16 offset:16384
    ds_read_b64_tr_b16 v[32:33], v20 offset:24576
    ds_read_b64_tr_b16 v[34:35], v20 offset:24832
    s_waitcnt lgkmcnt(9)
    v_mfma_f32_32x32x16_bf16 v[64:79], v[52:55], v[212:215], v[64:79]
    ds_read_b128 v[228:231], v17 offset:16384
    ds_read_b64_tr_b16 v[36:37], v20 offset:25600
    ds_read_b64_tr_b16 v[38:39], v20 offset:25856
    s_waitcnt lgkmcnt(9)
    v_mfma_f32_32x32x16_bf16 v[64:79], v[56:59], v[216:219], v[64:79]
    ds_read_b128 v[232:235], v18 offset:16384
    ds_read_b64_tr_b16 v[40:41], v20 offset:26624
    ds_read_b64_tr_b16 v[42:43], v20 offset:26880
    s_waitcnt lgkmcnt(9)
    v_mfma_f32_32x32x16_bf16 v[64:79], v[60:63], v[220:223], v[64:79]
    ds_read_b128 v[236:239], v19 offset:16384
    ds_read_b64_tr_b16 v[44:45], v20 offset:27648
    ds_read_b64_tr_b16 v[46:47], v20 offset:27904
    s_waitcnt lgkmcnt(9)
    v_mfma_f32_32x32x16_bf16 v[64:79], v[32:35], v[224:227], v[64:79]
    s_waitcnt lgkmcnt(6)
    v_mfma_f32_32x32x16_bf16 v[64:79], v[36:39], v[228:231], v[64:79]
    s_waitcnt lgkmcnt(3)
    v_mfma_f32_32x32x16_bf16 v[64:79], v[40:43], v[232:235], v[64:79]
    s_waitcnt lgkmcnt(0)
    v_mfma_f32_32x32x16_bf16 v[64:79], v[44:47], v[236:239], v[64:79]
    s_waitcnt lgkmcnt(0)
    s_lshr_b32 s36, s36, 16
    s_add_u32 s36, s36, 1
    s_and_b32 s36, s36, 0x9fff
    s_or_b32 s36, s36, 0x2000
    s_lshl_b32 s30, s36, 16
    s_or_b32 s36, s36, s30
    s_mov_b32 vcc_lo, 0
    s_mov_b32 vcc_hi, -1
    s_nop 2
    v_cvt_pk_bf16_f32 v96, v64, v65
    v_cvt_pk_bf16_f32 v97, v66, v67
    v_cvt_pk_bf16_f32 v98, v68, v69
    v_cvt_pk_bf16_f32 v99, v70, v71
    v_cvt_pk_bf16_f32 v100, v72, v73
    v_cvt_pk_bf16_f32 v101, v74, v75
    v_cvt_pk_bf16_f32 v102, v76, v77
    v_cvt_pk_bf16_f32 v103, v78, v79
    v_mfma_f32_32x32x16_bf16 v[80:95], v[248:251], v[96:99], 0
    s_nop 0
    v_mfma_f32_32x32x16_bf16 v[80:95], v[252:255], v[100:103], v[80:95]
    s_add_u32 m0, s59, 49152
    s_nop 0
    buffer_load_dwordx4 v14, s[16:19], s51 offen lds
    s_add_u32 m0, s59, 53248
    s_nop 0
    buffer_load_dwordx4 v14, s[16:19], s52 offen lds
    s_waitcnt vmcnt(3)
    s_barrier
    s_nop 3
    v_cndmask_b32 v92, v92, v94, vcc
    v_cndmask_b32 v93, v93, v95, vcc
    v_max3_f32 v24, v80, v81, v82
    v_max3_f32 v25, -v80, -v81, -v82
    v_max3_f32 v24, v24, v83, v84
    v_max3_f32 v25, v25, -v83, -v84
    v_max3_f32 v24, v24, v85, v86
    v_max3_f32 v25, v25, -v85, -v86
    v_max3_f32 v24, v24, v87, v88
    v_max3_f32 v25, v25, -v87, -v88
    v_max3_f32 v24, v24, v89, v90
    v_max3_f32 v25, v25, -v89, -v90
    v_max3_f32 v24, v24, v91, v92
    v_max3_f32 v25, v25, -v91, -v92
    v_max_f32 v24, v24, v93
    v_max_f32 v25, v25, -v93
    s_nop 1
    v_permlane32_swap_b32 v24, v25
    v_max_f32 v24, v24, v25
    v_mul_f32 v24, s69, v24
    v_mov_b32 v25, v24
    s_nop 1
    v_permlane32_swap_b32 v24, v25
    v_fma_f32 v96, v80, s69, v25
    v_fma_f32 v80, v80, s68, v24
    v_exp_f32 v96, v96
    v_exp_f32 v80, v80
    v_fma_f32 v97, v81, s69, v25
    v_fma_f32 v81, v81, s68, v24
    v_exp_f32 v97, v97
    v_exp_f32 v81, v81
    v_fma_f32 v98, v82, s69, v25
    v_fma_f32 v82, v82, s68, v24
    v_exp_f32 v98, v98
    v_exp_f32 v82, v82
    v_fma_f32 v99, v83, s69, v25
    v_fma_f32 v83, v83, s68, v24
    v_exp_f32 v99, v99
    v_exp_f32 v83, v83
    v_add_f32 v28, v96, v98
    v_add_f32 v26, v80, v82
    v_fma_f32 v100, v84, s69, v25
    v_fma_f32 v84, v84, s68, v24
    v_exp_f32 v100, v100
    v_exp_f32 v84, v84
    v_add_f32 v29, v97, v99
    v_add_f32 v27, v81, v83
    v_fma_f32 v101, v85, s69, v25
    v_fma_f32 v85, v85, s68, v24
    v_exp_f32 v101, v101
    v_exp_f32 v85, v85
    v_add_f32 v28, v28, v100
    v_add_f32 v26, v26, v84
    v_fma_f32 v102, v86, s69, v25
    v_fma_f32 v86, v86, s68, v24
    v_exp_f32 v102, v102
    v_exp_f32 v86, v86
    v_add_f32 v29, v29, v101
    v_add_f32 v27, v27, v85
    v_fma_f32 v103, v87, s69, v25
    v_fma_f32 v87, v87, s68, v24
    v_exp_f32 v103, v103
    v_exp_f32 v87, v87
    v_add_f32 v28, v28, v102
    v_add_f32 v26, v26, v86
    v_fma_f32 v104, v88, s69, v25
    v_fma_f32 v88, v88, s68, v24
    v_exp_f32 v104, v104
    v_exp_f32 v88, v88
    v_add_f32 v29, v29, v103
    v_add_f32 v27, v27, v87
    v_fma_f32 v105, v89, s69, v25
    v_fma_f32 v89, v89, s68, v24
    v_exp_f32 v105, v105
    v_exp_f32 v89, v89
    v_add_f32 v28, v28, v104
    v_add_f32 v26, v26, v88
    v_fma_f32 v106, v90, s69, v25
    v_fma_f32 v90, v90, s68, v24
    v_exp_f32 v106, v106
    v_exp_f32 v90, v90
    v_add_f32 v29, v29, v105
    v_add_f32 v27, v27, v89
    v_fma_f32 v107, v91, s69, v25
    v_fma_f32 v91, v91, s68, v24
    v_exp_f32 v107, v107
    v_exp_f32 v91, v91
    v_add_f32 v28, v28, v106
    v_add_f32 v26, v26, v90
    v_fma_f32 v108, v92, s69, v25
    v_fma_f32 v92, v92, s68, v24
    v_exp_f32 v108, v108
    s_waitcnt vmcnt(2)
    s_barrier
    v_exp_f32 v92, v92
    v_add_f32 v29, v29, v107
    v_add_f32 v27, v27, v91
    v_fma_f32 v109, v93, s69, v25
    v_fma_f32 v93, v93, s68, v24
    v_exp_f32 v109, v109
    v_exp_f32 v93, v93
    v_add_f32 v28, v28, v108
    v_add_f32 v26, v26, v92
    v_add_f32 v28, v28, v29
    v_add_f32 v26, v26, v27
    v_add_f32 v28, v28, v109
    v_add_f32 v26, v26, v93
    s_nop 1
    v_permlane32_swap_b32 v26, v28
    v_add_f32 v26, v26, v28
    v_rcp_f32 v26, v26
    s_nop 0
    v_mov_b32 v28, v26
    s_nop 1
    v_permlane32_swap_b32 v26, v28
    v_mul_f32 v80, v80, v26
    v_mul_f32 v81, v81, v26
    v_cvt_pk_bf16_f32 v112, v80, v81
    v_mul_f32 v82, v82, v26
    v_mul_f32 v83, v83, v26
    v_cvt_pk_bf16_f32 v113, v82, v83
    v_mul_f32 v84, v84, v26
    v_mul_f32 v85, v85, v26
    v_cvt_pk_bf16_f32 v114, v84, v85
    v_mul_f32 v86, v86, v26
    v_cvt_pk_bf16_f32 v115, v86, 0
    ds_write_b128 v240, v[112:115]
    v_mul_f32 v87, v87, v26
    v_mul_f32 v88, v88, v26
    v_cvt_pk_bf16_f32 v116, v87, v88
    v_mul_f32 v89, v89, v26
    v_mul_f32 v90, v90, v26
    v_cvt_pk_bf16_f32 v117, v89, v90
    v_mul_f32 v91, v91, v26
    v_mul_f32 v92, v92, v26
    v_cvt_pk_bf16_f32 v118, v91, v92
    v_mul_f32 v93, v93, v26
    v_cvt_pk_bf16_f32 v119, v93, 0
    ds_write_b128 v241, v[116:119]
    v_mul_f32 v96, v96, v28
    v_mul_f32 v97, v97, v28
    v_cvt_pk_bf16_f32 v120, v96, v97
    v_mul_f32 v98, v98, v28
    v_mul_f32 v99, v99, v28
    v_cvt_pk_bf16_f32 v121, v98, v99
    v_mul_f32 v100, v100, v28
    v_mul_f32 v101, v101, v28
    v_cvt_pk_bf16_f32 v122, v100, v101
    v_mul_f32 v102, v102, v28
    v_cvt_pk_bf16_f32 v123, v102, 0
    ds_write_b128 v242, v[120:123]
    v_mul_f32 v103, v103, v28
    v_mul_f32 v104, v104, v28
    v_cvt_pk_bf16_f32 v124, v103, v104
    v_mul_f32 v105, v105, v28
    v_mul_f32 v106, v106, v28
    v_cvt_pk_bf16_f32 v125, v105, v106
    v_mul_f32 v107, v107, v28
    v_mul_f32 v108, v108, v28
    v_cvt_pk_bf16_f32 v126, v107, v108
    v_mul_f32 v109, v109, v28
    v_cvt_pk_bf16_f32 v127, v109, 0
    ds_write_b128 v243, v[124:127]
    s_waitcnt lgkmcnt(0)
    s_barrier
    ds_read_b64_tr_b16 v[32:33], v244 offset:0
    ds_read_b64_tr_b16 v[34:35], v244 offset:2048
    ds_read_b64_tr_b16 v[48:49], v245 offset:0
    ds_read_b64_tr_b16 v[50:51], v245 offset:1024
    ds_read_b64_tr_b16 v[52:53], v246 offset:0
    ds_read_b64_tr_b16 v[54:55], v246 offset:1024
    ds_read_b64_tr_b16 v[36:37], v244 offset:4096
    ds_read_b64_tr_b16 v[38:39], v244 offset:6144
    ds_read_b64_tr_b16 v[56:57], v245 offset:2048
    ds_read_b64_tr_b16 v[58:59], v245 offset:3072
    ds_read_b64_tr_b16 v[60:61], v246 offset:2048
    ds_read_b64_tr_b16 v[62:63], v246 offset:3072
    ds_read_b64_tr_b16 v[40:41], v244 offset:8192
    ds_read_b64_tr_b16 v[42:43], v244 offset:10240
    ds_read_b64_tr_b16 v[64:65], v245 offset:4096
    ds_read_b64_tr_b16 v[66:67], v245 offset:5120
    ds_read_b64_tr_b16 v[68:69], v246 offset:4096
    ds_read_b64_tr_b16 v[70:71], v246 offset:5120
    ds_read_b64_tr_b16 v[44:45], v244 offset:12288
    ds_read_b64_tr_b16 v[46:47], v244 offset:14336
    ds_read_b64_tr_b16 v[72:73], v245 offset:6144
    ds_read_b64_tr_b16 v[74:75], v245 offset:7168
    ds_read_b64_tr_b16 v[76:77], v246 offset:6144
    ds_read_b64_tr_b16 v[78:79], v246 offset:7168
    s_waitcnt lgkmcnt(15)
    v_mfma_f32_16x16x32_bf16 v[80:83], v[32:35], v[48:51], 0
    v_mfma_f32_16x16x32_bf16 v[84:87], v[32:35], v[52:55], 0
    s_waitcnt lgkmcnt(14)
    v_mfma_f32_16x16x32_bf16 v[80:83], v[36:39], v[56:59], v[80:83]
    s_waitcnt lgkmcnt(12)
    v_mfma_f32_16x16x32_bf16 v[84:87], v[36:39], v[60:63], v[84:87]
    s_waitcnt lgkmcnt(8)
    v_mfma_f32_16x16x32_bf16 v[80:83], v[40:43], v[64:67], v[80:83]
    s_waitcnt lgkmcnt(6)
    v_mfma_f32_16x16x32_bf16 v[84:87], v[40:43], v[68:71], v[84:87]
    s_waitcnt lgkmcnt(2)
    v_mfma_f32_16x16x32_bf16 v[80:83], v[44:47], v[72:75], v[80:83]
    s_waitcnt lgkmcnt(0)
    v_mfma_f32_16x16x32_bf16 v[84:87], v[44:47], v[76:79], v[84:87]
    s_nop 5
    v_cvt_pk_bf16_f32 v88, v80, v81
    v_cvt_pk_bf16_f32 v89, v82, v83
    v_cvt_pk_bf16_f32 v90, v84, v85
    v_cvt_pk_bf16_f32 v91, v86, v87
    s_nop 1
    v_permlane16_swap_b32 v89, v91
    v_permlane16_swap_b32 v88, v90
    v_and_b32 v91, 0xffff, v91
    v_or_b32 v91, s30, v91
    buffer_store_dwordx4 v[88:91], v247, s[32:35], 0 offen sc1
    s_setprio 0
    s_waitcnt vmcnt(1)
    s_barrier
    ds_read_b64_tr_b16 v[32:33], v21 offset:0
    ds_read_b64_tr_b16 v[34:35], v21 offset:256
    ds_read_b64_tr_b16 v[36:37], v21 offset:1024
    ds_read_b64_tr_b16 v[38:39], v21 offset:1280
    ds_read_b64_tr_b16 v[40:41], v21 offset:2048
    ds_read_b64_tr_b16 v[42:43], v21 offset:2304
    ds_read_b64_tr_b16 v[44:45], v21 offset:3072
    ds_read_b64_tr_b16 v[46:47], v21 offset:3328
    s_waitcnt lgkmcnt(6)
    v_mfma_f32_32x32x16_bf16 v[64:79], v[32:35], v[128:131], 0
    ds_read_b64_tr_b16 v[48:49], v21 offset:4096
    ds_read_b64_tr_b16 v[50:51], v21 offset:4352
    s_waitcnt lgkmcnt(6)
    v_mfma_f32_32x32x16_bf16 v[64:79], v[36:39], v[132:135], v[64:79]
    ds_read_b64_tr_b16 v[52:53], v21 offset:5120
    ds_read_b64_tr_b16 v[54:55], v21 offset:5376
    s_waitcnt lgkmcnt(6)
    v_mfma_f32_32x32x16_bf16 v[64:79], v[40:43], v[136:139], v[64:79]
    ds_read_b64_tr_b16 v[56:57], v21 offset:6144
    ds_read_b64_tr_b16 v[58:59], v21 offset:6400
    ds_read_b64_tr_b16 v[248:249], v22 offset:2048
    ds_read_b64_tr_b16 v[250:251], v22 offset:2560
    ds_read_b64_tr_b16 v[252:253], v22 offset:3072
    ds_read_b64_tr_b16 v[254:255], v22 offset:3584
    v_and_b32 v4, 31, v1
    v_lshlrev_b32 v4, 2, v4
    s_waitcnt lgkmcnt(10)
    v_mfma_f32_32x32x16_bf16 v[64:79], v[44:47], v[140:143], v[64:79]
    ds_read_b64_tr_b16 v[60:61], v21 offset:7168
    ds_read_b64_tr_b16 v[62:63], v21 offset:7424
    s_lshl_b32 s60, s8, 7
    s_add_u32 s60, s60, 77824
    v_add_u32 v12, s60, v4
    s_lshl_b32 s60, s7, 8
    s_add_u32 s60, s60, 5308416
    s_waitcnt lgkmcnt(10)
    v_mfma_f32_32x32x16_bf16 v[64:79], v[48:51], v[144:147], v[64:79]
    ds_read_b64_tr_b16 v[32:33], v21 offset:8192
    ds_read_b64_tr_b16 v[34:35], v21 offset:8448
    s_cmp_eq_u32 s5, 0
    s_cselect_b32 s60, s60, 0x7ffff000
    v_lshl_add_u32 v11, v4, 1, s60
    v_bfe_u32 v4, v1, 4, 1
    v_bfe_u32 v5, v1, 2, 1
    v_lshl_add_u32 v4, v4, 1, v5
    s_waitcnt lgkmcnt(10)
    v_mfma_f32_32x32x16_bf16 v[64:79], v[52:55], v[148:151], v[64:79]
    ds_read_b64_tr_b16 v[36:37], v21 offset:9216
    ds_read_b64_tr_b16 v[38:39], v21 offset:9472
    v_bfe_u32 v5, v1, 3, 1
    v_and_b32 v6, 3, v1
    v_lshl_add_u32 v5, v5, 2, v6
    v_mad_u32_u24 v4, v4, 7, v5
    v_cmp_eq_u32 vcc, 7, v5
    s_waitcnt lgkmcnt(10)
    v_mfma_f32_32x32x16_bf16 v[64:79], v[56:59], v[152:155], v[64:79]
    ds_read_b64_tr_b16 v[40:41], v21 offset:10240
    ds_read_b64_tr_b16 v[42:43], v21 offset:10496
    v_cndmask_b32 v4, v4, 28, vcc
    v_lshrrev_b32 v5, 5, v1
    v_lshl_add_u32 v4, v5, 5, v4
    v_lshlrev_b32 v4, 4, v4
    v_add_u32 v13, 152064, v4
    s_waitcnt lgkmcnt(6)
    v_mfma_f32_32x32x16_bf16 v[64:79], v[60:63], v[156:159], v[64:79]
    ds_read_b64_tr_b16 v[44:45], v21 offset:11264
    ds_read_b64_tr_b16 v[46:47], v21 offset:11520
    s_lshr_b32 s60, s8, 1
    s_lshl_b32 s60, s60, 5
    s_add_u32 s60, s60, s9
    s_and_b32 s61, s8, 1
    s_lshl_b32 s62, s61, 10
    s_add_u32 s63, s62, s60
    s_waitcnt lgkmcnt(6)
    v_mfma_f32_32x32x16_bf16 v[64:79], v[32:35], v[160:163], v[64:79]
    ds_read_b64_tr_b16 v[48:49], v21 offset:12288
    ds_read_b64_tr_b16 v[50:51], v21 offset:12544
    v_and_b32 v4, 15, v1
    v_lshrrev_b32 v5, 4, v1
    v_lshl_add_u32 v6, v4, 6, s63
    v_cvt_f32_u32 v7, v6
    v_mul_f32 v7, 0x3a000000, v7
    s_waitcnt lgkmcnt(6)
    v_mfma_f32_32x32x16_bf16 v[64:79], v[36:39], v[164:167], v[64:79]
    ds_read_b64_tr_b16 v[52:53], v21 offset:13312
    ds_read_b64_tr_b16 v[54:55], v21 offset:13568
    v_lshl_add_u32 v8, v5, 2, 0
    v_cvt_f32_u32 v8, v8
    v_mul_f32 v8, v8, v7
    s_cmp_ge_u32 s10, 4
    s_cselect_b32 s64, 0x80000000, 0
    s_waitcnt lgkmcnt(6)
    v_mfma_f32_32x32x16_bf16 v[64:79], v[40:43], v[168:171], v[64:79]
    ds_read_b64_tr_b16 v[56:57], v21 offset:14336
    ds_read_b64_tr_b16 v[58:59], v21 offset:14592
    s_cmp_ge_u32 s10, 3
    s_cselect_b32 s65, 0x80000000, 0
    s_movk_i32 s66, 896
    v_mul_u32_u24 v15, s66, v6
    v_and_b32 v6, 1, v5
    v_lshl_add_u32 v15, v6, 5, v15
    s_waitcnt lgkmcnt(6)
    v_mfma_f32_32x32x16_bf16 v[64:79], v[44:47], v[172:175], v[64:79]
    ds_read_b64_tr_b16 v[60:61], v21 offset:15360
    ds_read_b64_tr_b16 v[62:63], v21 offset:15616
    v_lshrrev_b32 v6, 1, v5
    v_lshl_add_u32 v15, v6, 4, v15
    s_lshl_b32 s66, s10, 7
    s_add_u32 s66, s66, 0
    v_add_u32 v15, s66, v15
    s_waitcnt lgkmcnt(6)
    v_mfma_f32_32x32x16_bf16 v[64:79], v[48:51], v[176:179], v[64:79]
    ds_read_b64_tr_b16 v[32:33], v21 offset:16384
    ds_read_b64_tr_b16 v[34:35], v21 offset:16640
    s_lshl_b32 s60, s60, 1
    s_add_u32 s60, s60, s61
    s_lshl_b32 s66, s60, 7
    s_add_u32 s66, s66, 5308416
    v_lshl_add_u32 v29, v4, 3, s66
    s_lshl_b32 s60, s60, 14
    s_waitcnt lgkmcnt(6)
    v_mfma_f32_32x32x16_bf16 v[64:79], v[52:55], v[180:183], v[64:79]
    ds_read_b64_tr_b16 v[36:37], v21 offset:17408
    ds_read_b64_tr_b16 v[38:39], v21 offset:17664
    s_add_u32 s60, s60, 0
    v_add_u32 v14, s60, v3
    v_lshlrev_b32 v23, 4, v4
    v_lshl_add_u32 v23, v5, 10, v23
    v_add_u32 v23, 32768, v23
    s_waitcnt lgkmcnt(6)
    v_mfma_f32_32x32x16_bf16 v[64:79], v[56:59], v[184:187], v[64:79]
    ds_read_b64_tr_b16 v[40:41], v21 offset:18432
    ds_read_b64_tr_b16 v[42:43], v21 offset:18688
    v_mov_b32 v9, v8
    v_cos_f32 v6, v9
    v_sin_f32 v9, v9
    s_nop 0
    v_cvt_pk_bf16_f32 v96, v6, v9
    v_xor_b32 v104, s65, v96
    s_waitcnt lgkmcnt(6)
    v_mfma_f32_32x32x16_bf16 v[64:79], v[60:63], v[188:191], v[64:79]
    ds_read_b64_tr_b16 v[44:45], v21 offset:19456
    ds_read_b64_tr_b16 v[46:47], v21 offset:19712
    v_xor_b32 v96, s64, v96
    v_fmamk_f32 v9, v7, 0x3f800000, v8
    v_cos_f32 v6, v9
    v_sin_f32 v9, v9
    s_nop 0
    v_cvt_pk_bf16_f32 v97, v6, v9
    v_xor_b32 v105, s65, v97
    s_waitcnt lgkmcnt(6)
    v_mfma_f32_32x32x16_bf16 v[64:79], v[32:35], v[192:195], v[64:79]
    ds_read_b64_tr_b16 v[48:49], v21 offset:20480
    ds_read_b64_tr_b16 v[50:51], v21 offset:20736
    v_xor_b32 v97, s64, v97
    v_fmamk_f32 v9, v7, 0x40000000, v8
    v_cos_f32 v6, v9
    v_sin_f32 v9, v9
    s_nop 0
    v_cvt_pk_bf16_f32 v98, v6, v9
    s_waitcnt lgkmcnt(6)
    v_mfma_f32_32x32x16_bf16 v[64:79], v[36:39], v[196:199], v[64:79]
    ds_read_b64_tr_b16 v[52:53], v21 offset:21504
    ds_read_b64_tr_b16 v[54:55], v21 offset:21760
    v_xor_b32 v106, s65, v98
    v_xor_b32 v98, s64, v98
    v_fmamk_f32 v9, v7, 0x40400000, v8
    v_cos_f32 v6, v9
    v_sin_f32 v9, v9
    s_waitcnt lgkmcnt(6)
    v_mfma_f32_32x32x16_bf16 v[64:79], v[40:43], v[200:203], v[64:79]
    ds_read_b64_tr_b16 v[56:57], v21 offset:22528
    ds_read_b64_tr_b16 v[58:59], v21 offset:22784
    v_cvt_pk_bf16_f32 v99, v6, v9
    v_xor_b32 v107, s65, v99
    v_xor_b32 v99, s64, v99
    v_fmamk_f32 v9, v7, 0x41800000, v8
    v_cos_f32 v6, v9
    v_sin_f32 v9, v9
    s_waitcnt lgkmcnt(6)
    v_mfma_f32_32x32x16_bf16 v[64:79], v[44:47], v[204:207], v[64:79]
    ds_read_b64_tr_b16 v[60:61], v21 offset:23552
    ds_read_b64_tr_b16 v[62:63], v21 offset:23808
    v_cvt_pk_bf16_f32 v100, v6, v9
    v_xor_b32 v108, s65, v100
    v_xor_b32 v100, s64, v100
    v_fmamk_f32 v9, v7, 0x41880000, v8
    v_cos_f32 v6, v9
    s_waitcnt lgkmcnt(6)
    v_mfma_f32_32x32x16_bf16 v[64:79], v[48:51], v[208:211], v[64:79]
    ds_read_b64_tr_b16 v[32:33], v21 offset:24576
    ds_read_b64_tr_b16 v[34:35], v21 offset:24832
    v_sin_f32 v9, v9
    s_nop 0
    v_cvt_pk_bf16_f32 v101, v6, v9
    v_xor_b32 v109, s65, v101
    v_xor_b32 v101, s64, v101
    v_fmamk_f32 v9, v7, 0x41900000, v8
    v_cos_f32 v6, v9
    s_waitcnt lgkmcnt(6)
    v_mfma_f32_32x32x16_bf16 v[64:79], v[52:55], v[212:215], v[64:79]
    ds_read_b64_tr_b16 v[36:37], v21 offset:25600
    ds_read_b64_tr_b16 v[38:39], v21 offset:25856
    v_sin_f32 v9, v9
    s_nop 0
    v_cvt_pk_bf16_f32 v102, v6, v9
    v_xor_b32 v110, s65, v102
    v_xor_b32 v102, s64, v102
    v_fmamk_f32 v9, v7, 0x41980000, v8
    s_waitcnt lgkmcnt(6)
    v_mfma_f32_32x32x16_bf16 v[64:79], v[56:59], v[216:219], v[64:79]
    ds_read_b64_tr_b16 v[40:41], v21 offset:26624
    ds_read_b64_tr_b16 v[42:43], v21 offset:26880
    v_cos_f32 v6, v9
    v_sin_f32 v9, v9
    s_nop 0
    v_cvt_pk_bf16_f32 v103, v6, v9
    v_xor_b32 v111, s65, v103
    v_xor_b32 v103, s64, v103
    s_waitcnt lgkmcnt(6)
    v_mfma_f32_32x32x16_bf16 v[64:79], v[60:63], v[220:223], v[64:79]
    ds_read_b64_tr_b16 v[44:45], v21 offset:27648
    ds_read_b64_tr_b16 v[46:47], v21 offset:27904
    v_bfe_u32 v6, v1, 2, 2
    v_mad_u32_u24 v6, v5, 7, v6
    v_bfe_u32 v7, v1, 3, 2
    v_bfe_u32 v8, v1, 1, 1
    v_lshl_or_b32 v8, v7, 1, v8
    v_lshlrev_b32 v8, 4, v8
    s_waitcnt lgkmcnt(6)
    v_mfma_f32_32x32x16_bf16 v[64:79], v[32:35], v[224:227], v[64:79]
    v_lshl_add_u32 v8, v6, 7, v8
    v_and_b32 v7, 1, v1
    v_lshl_add_u32 v8, v7, 3, v8
    v_add_u32 v24, 81920, v8
    v_xor_b32 v25, 32, v24
    s_waitcnt lgkmcnt(4)
    v_mfma_f32_32x32x16_bf16 v[64:79], v[36:39], v[228:231], v[64:79]
    v_xor_b32 v26, 64, v24
    v_xor_b32 v27, 0x60, v24
    s_lshl_b32 s60, s3, 11
    v_add_u32 v28, s60, v3
    v_xor_b32 v30, 0x2000, v28
    s_waitcnt lgkmcnt(2)
    v_mfma_f32_32x32x16_bf16 v[64:79], v[40:43], v[232:235], v[64:79]
    s_waitcnt lgkmcnt(0)
    v_mfma_f32_32x32x16_bf16 v[64:79], v[44:47], v[236:239], v[64:79]
    ds_read_b32 v31, v12
    s_mov_b32 vcc_lo, 0
    s_mov_b32 vcc_hi, -1
    s_nop 8
    v_cvt_pk_bf16_f32 v32, v64, v65
    v_cvt_pk_bf16_f32 v33, v66, v67
    v_cvt_pk_bf16_f32 v34, v68, v69
    v_cvt_pk_bf16_f32 v35, v70, v71
    v_cvt_pk_bf16_f32 v36, v72, v73
    v_cvt_pk_bf16_f32 v37, v74, v75
    v_cvt_pk_bf16_f32 v38, v76, v77
    v_cvt_pk_bf16_f32 v39, v78, v79
    v_mfma_f32_32x32x16_bf16 v[80:95], v[248:251], v[32:35], 0
    s_nop 0
    v_mfma_f32_32x32x16_bf16 v[80:95], v[252:255], v[36:39], v[80:95]
    s_waitcnt lgkmcnt(0)
    v_mul_f32 v31, s68, v31
    v_exp_f32 v31, v31
    s_nop 0
    v_add_f32 v31, 1.0, v31
    v_rcp_f32 v31, v31
    s_nop 0
    v_sub_f32 v4, 1.0, v31
    v_mov_b32 v5, s36
    s_mov_b32 exec_hi, 0
    buffer_store_dwordx2 v[4:5], v11, s[32:35], 0 offen sc1
    s_mov_b32 exec_hi, -1
    v_cndmask_b32 v92, v92, v94, vcc
    v_cndmask_b32 v93, v93, v95, vcc
    v_max3_f32 v16, v80, v81, v82
    v_max3_f32 v17, -v80, -v81, -v82
    v_max3_f32 v16, v16, v83, v84
    v_max3_f32 v17, v17, -v83, -v84
    v_max3_f32 v16, v16, v85, v86
    v_max3_f32 v17, v17, -v85, -v86
    v_max3_f32 v16, v16, v87, v88
    v_max3_f32 v17, v17, -v87, -v88
    v_max3_f32 v16, v16, v89, v90
    v_max3_f32 v17, v17, -v89, -v90
    v_max3_f32 v16, v16, v91, v92
    v_max3_f32 v17, v17, -v91, -v92
    v_max_f32 v16, v16, v93
    v_max_f32 v17, v17, -v93
    s_nop 1
    v_permlane32_swap_b32 v16, v17
    v_max_f32 v16, v16, v17
    v_mul_f32 v16, s69, v16
    v_mov_b32 v17, v16
    s_nop 1
    v_permlane32_swap_b32 v16, v17
    v_fma_f32 v64, v80, s69, v17
    v_fma_f32 v80, v80, s68, v16
    v_exp_f32 v64, v64
    v_exp_f32 v80, v80
    v_fma_f32 v65, v81, s69, v17
    v_fma_f32 v81, v81, s68, v16
    v_exp_f32 v65, v65
    v_exp_f32 v81, v81
    v_fma_f32 v66, v82, s69, v17
    v_fma_f32 v82, v82, s68, v16
    v_exp_f32 v66, v66
    v_exp_f32 v82, v82
    v_fma_f32 v67, v83, s69, v17
    v_fma_f32 v83, v83, s68, v16
    v_exp_f32 v67, v67
    v_exp_f32 v83, v83
    v_add_f32 v20, v64, v66
    v_add_f32 v18, v80, v82
    v_fma_f32 v68, v84, s69, v17
    v_fma_f32 v84, v84, s68, v16
    v_exp_f32 v68, v68
    v_exp_f32 v84, v84
    v_add_f32 v21, v65, v67
    v_add_f32 v19, v81, v83
    v_fma_f32 v69, v85, s69, v17
    v_fma_f32 v85, v85, s68, v16
    v_exp_f32 v69, v69
    v_exp_f32 v85, v85
    v_add_f32 v20, v20, v68
    v_add_f32 v18, v18, v84
    v_fma_f32 v70, v86, s69, v17
    v_fma_f32 v86, v86, s68, v16
    v_exp_f32 v70, v70
    v_exp_f32 v86, v86
    v_add_f32 v21, v21, v69
    v_add_f32 v19, v19, v85
    v_fma_f32 v71, v87, s69, v17
    v_fma_f32 v87, v87, s68, v16
    v_exp_f32 v71, v71
    v_exp_f32 v87, v87
    v_add_f32 v20, v20, v70
    v_add_f32 v18, v18, v86
    v_fma_f32 v72, v88, s69, v17
    v_fma_f32 v88, v88, s68, v16
    v_exp_f32 v72, v72
    v_exp_f32 v88, v88
    v_add_f32 v21, v21, v71
    v_add_f32 v19, v19, v87
    v_fma_f32 v73, v89, s69, v17
    v_fma_f32 v89, v89, s68, v16
    v_exp_f32 v73, v73
    v_exp_f32 v89, v89
    v_add_f32 v20, v20, v72
    v_add_f32 v18, v18, v88
    v_fma_f32 v74, v90, s69, v17
    v_fma_f32 v90, v90, s68, v16
    v_exp_f32 v74, v74
    v_exp_f32 v90, v90
    v_add_f32 v21, v21, v73
    v_add_f32 v19, v19, v89
    v_fma_f32 v75, v91, s69, v17
    v_fma_f32 v91, v91, s68, v16
    v_exp_f32 v75, v75
    v_exp_f32 v91, v91
    v_add_f32 v20, v20, v74
    v_add_f32 v18, v18, v90
    v_fma_f32 v76, v92, s69, v17
    v_fma_f32 v92, v92, s68, v16
    v_exp_f32 v76, v76
    v_exp_f32 v92, v92
    v_add_f32 v21, v21, v75
    v_add_f32 v19, v19, v91
    v_fma_f32 v77, v93, s69, v17
    v_fma_f32 v93, v93, s68, v16
    v_exp_f32 v77, v77
    v_exp_f32 v93, v93
    v_add_f32 v20, v20, v76
    v_add_f32 v18, v18, v92
    v_add_f32 v20, v20, v21
    v_add_f32 v18, v18, v19
    v_add_f32 v20, v20, v77
    v_add_f32 v18, v18, v93
    s_nop 1
    v_permlane32_swap_b32 v18, v20
    v_add_f32 v18, v18, v20
    v_rcp_f32 v18, v18
    s_nop 0
    v_mov_b32 v20, v18
    s_nop 1
    v_permlane32_swap_b32 v18, v20
    v_mul_f32 v80, v80, v18
    v_mul_f32 v81, v81, v18
    v_cvt_pk_bf16_f32 v112, v80, v81
    v_mul_f32 v82, v82, v18
    v_mul_f32 v83, v83, v18
    v_cvt_pk_bf16_f32 v113, v82, v83
    v_mul_f32 v84, v84, v18
    v_mul_f32 v85, v85, v18
    v_cvt_pk_bf16_f32 v114, v84, v85
    v_mul_f32 v86, v86, v18
    v_cvt_pk_bf16_f32 v115, v86, 0
    v_mul_f32 v87, v87, v18
    v_mul_f32 v88, v88, v18
    v_cvt_pk_bf16_f32 v116, v87, v88
    v_mul_f32 v89, v89, v18
    v_mul_f32 v90, v90, v18
    v_cvt_pk_bf16_f32 v117, v89, v90
    v_mul_f32 v91, v91, v18
    v_mul_f32 v92, v92, v18
    v_cvt_pk_bf16_f32 v118, v91, v92
    v_mul_f32 v93, v93, v18
    v_cvt_pk_bf16_f32 v119, v93, 0
    v_mul_f32 v64, v64, v20
    v_mul_f32 v65, v65, v20
    v_cvt_pk_bf16_f32 v120, v64, v65
    v_mul_f32 v66, v66, v20
    v_mul_f32 v67, v67, v20
    v_cvt_pk_bf16_f32 v121, v66, v67
    v_mul_f32 v68, v68, v20
    v_mul_f32 v69, v69, v20
    v_cvt_pk_bf16_f32 v122, v68, v69
    v_mul_f32 v70, v70, v20
    v_cvt_pk_bf16_f32 v123, v70, 0
    v_mul_f32 v71, v71, v20
    v_mul_f32 v72, v72, v20
    v_cvt_pk_bf16_f32 v124, v71, v72
    v_mul_f32 v73, v73, v20
    v_mul_f32 v74, v74, v20
    v_cvt_pk_bf16_f32 v125, v73, v74
    v_mul_f32 v75, v75, v20
    v_mul_f32 v76, v76, v20
    v_cvt_pk_bf16_f32 v126, v75, v76
    v_mul_f32 v77, v77, v20
    v_cvt_pk_bf16_f32 v127, v77, 0
    s_setprio 2
    s_barrier
    ds_read_b128 v[32:35], v13 offset:0
    ds_read_b128 v[36:39], v13 offset:1024
    ds_read_b128 v[40:43], v13 offset:2048
    ds_read_b128 v[44:47], v13 offset:3072
    s_waitcnt lgkmcnt(3)
    v_mfma_f32_32x32x16_bf16 v[80:95], v[32:35], v[112:115], 0
    s_waitcnt lgkmcnt(2)
    v_mfma_f32_32x32x16_bf16 v[80:95], v[36:39], v[116:119], v[80:95]
    s_waitcnt lgkmcnt(1)
    v_mfma_f32_32x32x16_bf16 v[80:95], v[40:43], v[120:123], v[80:95]
    s_waitcnt lgkmcnt(0)
    v_mfma_f32_32x32x16_bf16 v[80:95], v[44:47], v[124:127], v[80:95]
    s_nop 11
    v_add_f32 v6, 0x358637bd, v87
    v_rcp_f32 v6, v6
    s_nop 0
    v_mul_f32 v6, v6, v31
    v_mul_f32 v80, v80, v6
    v_mul_f32 v81, v81, v6
    v_mul_f32 v82, v82, v6
    v_mul_f32 v83, v83, v6
    v_mul_f32 v84, v84, v6
    v_mul_f32 v85, v85, v6
    v_mul_f32 v86, v86, v6
    v_cvt_pk_bf16_f32 v48, v80, v81
    v_cvt_pk_bf16_f32 v49, v82, v83
    v_cvt_pk_bf16_f32 v50, v84, v85
    v_cvt_pk_bf16_f32 v51, v86, s30
    buffer_store_dwordx4 v[48:51], v2, s[32:35], 0 offen offset:0 sc1
    v_mul_f32 v88, v88, v6
    v_mul_f32 v89, v89, v6
    v_mul_f32 v90, v90, v6
    v_mul_f32 v91, v91, v6
    v_mul_f32 v92, v92, v6
    v_mul_f32 v93, v93, v6
    v_mul_f32 v94, v94, v6
    v_cvt_pk_bf16_f32 v52, v88, v89
    v_cvt_pk_bf16_f32 v53, v90, v91
    v_cvt_pk_bf16_f32 v54, v92, v93
    v_cvt_pk_bf16_f32 v55, v94, s30
    buffer_store_dwordx4 v[52:55], v2, s[32:35], 0 offen offset:512 sc1
    s_setprio 0
    s_cmp_ge_u32 s10, 7
    s_cbranch_scc1 A_FIN
    ds_read_b64_tr_b16 v[128:129], v24 offset:0
    ds_read_b64_tr_b16 v[130:131], v24 offset:512
    ds_read_b64_tr_b16 v[132:133], v25 offset:0
    ds_read_b64_tr_b16 v[134:135], v25 offset:512
    ds_read_b64_tr_b16 v[136:137], v26 offset:0
    ds_read_b64_tr_b16 v[138:139], v26 offset:512
    ds_read_b64_tr_b16 v[140:141], v27 offset:0
    ds_read_b64_tr_b16 v[142:143], v27 offset:512
    ds_read_b64_tr_b16 v[144:145], v24 offset:3584
    ds_read_b64_tr_b16 v[146:147], v24 offset:4096
    ds_read_b64_tr_b16 v[148:149], v25 offset:3584
    ds_read_b64_tr_b16 v[150:151], v25 offset:4096
    ds_read_b64_tr_b16 v[152:153], v26 offset:3584
    ds_read_b64_tr_b16 v[154:155], v26 offset:4096
    ds_read_b64_tr_b16 v[156:157], v27 offset:3584
    ds_read_b64_tr_b16 v[158:159], v27 offset:4096
    ds_read_b64_tr_b16 v[160:161], v24 offset:7168
    ds_read_b64_tr_b16 v[162:163], v24 offset:7680
    ds_read_b64_tr_b16 v[164:165], v25 offset:7168
    ds_read_b64_tr_b16 v[166:167], v25 offset:7680
    ds_read_b64_tr_b16 v[168:169], v26 offset:7168
    ds_read_b64_tr_b16 v[170:171], v26 offset:7680
    ds_read_b64_tr_b16 v[172:173], v27 offset:7168
    ds_read_b64_tr_b16 v[174:175], v27 offset:7680
    ds_read_b64_tr_b16 v[176:177], v24 offset:10752
    ds_read_b64_tr_b16 v[178:179], v24 offset:11264
    ds_read_b64_tr_b16 v[180:181], v25 offset:10752
    ds_read_b64_tr_b16 v[182:183], v25 offset:11264
    ds_read_b64_tr_b16 v[184:185], v26 offset:10752
    ds_read_b64_tr_b16 v[186:187], v26 offset:11264
    ds_read_b64_tr_b16 v[188:189], v27 offset:10752
    ds_read_b64_tr_b16 v[190:191], v27 offset:11264
    ds_read_b64_tr_b16 v[192:193], v24 offset:14336
    ds_read_b64_tr_b16 v[194:195], v24 offset:14848
    ds_read_b64_tr_b16 v[196:197], v25 offset:14336
    ds_read_b64_tr_b16 v[198:199], v25 offset:14848
    ds_read_b64_tr_b16 v[200:201], v26 offset:14336
    ds_read_b64_tr_b16 v[202:203], v26 offset:14848
    ds_read_b64_tr_b16 v[204:205], v27 offset:14336
    ds_read_b64_tr_b16 v[206:207], v27 offset:14848
    ds_read_b64_tr_b16 v[208:209], v24 offset:17920
    ds_read_b64_tr_b16 v[210:211], v24 offset:18432
    ds_read_b64_tr_b16 v[212:213], v25 offset:17920
    ds_read_b64_tr_b16 v[214:215], v25 offset:18432
    ds_read_b64_tr_b16 v[216:217], v26 offset:17920
    ds_read_b64_tr_b16 v[218:219], v26 offset:18432
    ds_read_b64_tr_b16 v[220:221], v27 offset:17920
    ds_read_b64_tr_b16 v[222:223], v27 offset:18432
    ds_read_b64_tr_b16 v[224:225], v24 offset:21504
    ds_read_b64_tr_b16 v[226:227], v24 offset:22016
    ds_read_b64_tr_b16 v[228:229], v25 offset:21504
    ds_read_b64_tr_b16 v[230:231], v25 offset:22016
    ds_read_b64_tr_b16 v[232:233], v26 offset:21504
    ds_read_b64_tr_b16 v[234:235], v26 offset:22016
    ds_read_b64_tr_b16 v[236:237], v27 offset:21504
    ds_read_b64_tr_b16 v[238:239], v27 offset:22016
    ds_read_b64_tr_b16 v[240:241], v24 offset:25088
    ds_read_b64_tr_b16 v[242:243], v24 offset:25600
    ds_read_b64_tr_b16 v[244:245], v25 offset:25088
    ds_read_b64_tr_b16 v[246:247], v25 offset:25600
    ds_read_b64_tr_b16 v[248:249], v26 offset:25088
    ds_read_b64_tr_b16 v[250:251], v26 offset:25600
    ds_read_b64_tr_b16 v[252:253], v27 offset:25088
    ds_read_b64_tr_b16 v[254:255], v27 offset:25600
    buffer_load_dwordx2 v[20:21], v29, s[32:35], 0 offen sc1
    s_barrier
    ds_read_b128 v[64:67], v23 offset:0
    ds_read_b128 v[68:71], v23 offset:256
    ds_read_b128 v[72:75], v23 offset:512
    ds_read_b128 v[76:79], v23 offset:768
    ds_read_b128 v[80:83], v23 offset:4096
    ds_read_b128 v[84:87], v23 offset:4352
    ds_read_b128 v[88:91], v23 offset:4608
    ds_read_b128 v[92:95], v23 offset:4864
    s_waitcnt lgkmcnt(7)
    v_mfma_f32_16x16x32_bf16 v[112:115], v[64:67], v[96:99], 0
    s_waitcnt lgkmcnt(6)
    v_mfma_f32_16x16x32_bf16 v[116:119], v[68:71], v[96:99], 0
    s_waitcnt lgkmcnt(5)
    v_mfma_f32_16x16x32_bf16 v[120:123], v[72:75], v[104:107], 0
    s_waitcnt lgkmcnt(4)
    v_mfma_f32_16x16x32_bf16 v[124:127], v[76:79], v[104:107], 0
    s_waitcnt lgkmcnt(3)
    v_mfma_f32_16x16x32_bf16 v[112:115], v[80:83], v[100:103], v[112:115]
    s_waitcnt lgkmcnt(2)
    v_mfma_f32_16x16x32_bf16 v[116:119], v[84:87], v[100:103], v[116:119]
    s_waitcnt lgkmcnt(1)
    v_mfma_f32_16x16x32_bf16 v[120:123], v[88:91], v[108:111], v[120:123]
    s_waitcnt lgkmcnt(0)
    v_mfma_f32_16x16x32_bf16 v[124:127], v[92:95], v[108:111], v[124:127]
    s_movk_i32 s60, 4096
    buffer_load_dwordx4 v[32:35], v14, s[32:35], 0 offen sc1
    buffer_load_dwordx4 v[36:39], v14, s[32:35], 0 offen offset:1024 sc1
    buffer_load_dwordx4 v[40:43], v14, s[32:35], 0 offen offset:2048 sc1
    buffer_load_dwordx4 v[44:47], v14, s[32:35], 0 offen offset:3072 sc1
    buffer_load_dwordx4 v[48:51], v14, s[32:35], s60 offen sc1
    buffer_load_dwordx4 v[52:55], v14, s[32:35], s60 offen offset:1024 sc1
    buffer_load_dwordx4 v[56:59], v14, s[32:35], s60 offen offset:2048 sc1
    buffer_load_dwordx4 v[60:63], v14, s[32:35], s60 offen offset:3072 sc1
    s_movk_i32 s67, 400
GA_CK0:
    s_waitcnt vmcnt(8)
    v_cmp_ne_u32 vcc, s36, v21
    s_cbranch_vccnz GA_RT0
GA_OK0:
    v_mul_f32 v112, v112, v20
    v_mul_f32 v113, v113, v20
    v_mul_f32 v114, v114, v20
    v_mul_f32 v115, v115, v20
    v_mul_f32 v116, v116, v20
    v_mul_f32 v117, v117, v20
    v_mul_f32 v118, v118, v20
    v_mul_f32 v119, v119, v20
    v_mul_f32 v120, v120, v20
    v_mul_f32 v121, v121, v20
    v_mul_f32 v122, v122, v20
    v_mul_f32 v123, v123, v20
    v_mul_f32 v124, v124, v20
    v_mul_f32 v125, v125, v20
    v_mul_f32 v126, v126, v20
    v_mul_f32 v127, v127, v20
    s_movk_i32 s67, 400
OA_CK0:
    s_waitcnt vmcnt(7)
    v_cmp_ne_u32_sdwa vcc, v35, s36 src0_sel:WORD_1 src1_sel:WORD_1
    v_and_b32 v35, 0xffff, v35
    s_cbranch_vccnz OA_RT0
OA_OK0:
    s_nop 0
    v_mfma_f32_16x16x32_bf16 v[120:123], v[136:139], v[32:35], v[120:123]
    v_mfma_f32_16x16x32_bf16 v[124:127], v[140:143], v[32:35], v[124:127]
    v_mfma_f32_16x16x32_bf16 v[112:115], v[128:131], v[32:35], v[112:115]
    v_mfma_f32_16x16x32_bf16 v[116:119], v[132:135], v[32:35], v[116:119]
OA_CK1:
    s_waitcnt vmcnt(6)
    v_cmp_ne_u32_sdwa vcc, v39, s36 src0_sel:WORD_1 src1_sel:WORD_1
    v_and_b32 v39, 0xffff, v39
    s_cbranch_vccnz OA_RT1
OA_OK1:
    s_nop 0
    v_mfma_f32_16x16x32_bf16 v[120:123], v[152:155], v[36:39], v[120:123]
    v_mfma_f32_16x16x32_bf16 v[124:127], v[156:159], v[36:39], v[124:127]
    v_mfma_f32_16x16x32_bf16 v[112:115], v[144:147], v[36:39], v[112:115]
    v_mfma_f32_16x16x32_bf16 v[116:119], v[148:151], v[36:39], v[116:119]
OA_CK2:
    s_waitcnt vmcnt(5)
    v_cmp_ne_u32_sdwa vcc, v43, s36 src0_sel:WORD_1 src1_sel:WORD_1
    v_and_b32 v43, 0xffff, v43
    s_cbranch_vccnz OA_RT2
OA_OK2:
    s_nop 0
    v_mfma_f32_16x16x32_bf16 v[120:123], v[168:171], v[40:43], v[120:123]
    v_mfma_f32_16x16x32_bf16 v[124:127], v[172:175], v[40:43], v[124:127]
    v_mfma_f32_16x16x32_bf16 v[112:115], v[160:163], v[40:43], v[112:115]
    v_mfma_f32_16x16x32_bf16 v[116:119], v[164:167], v[40:43], v[116:119]
OA_CK3:
    s_waitcnt vmcnt(4)
    v_cmp_ne_u32_sdwa vcc, v47, s36 src0_sel:WORD_1 src1_sel:WORD_1
    v_and_b32 v47, 0xffff, v47
    s_cbranch_vccnz OA_RT3
OA_OK3:
    s_nop 0
    v_mfma_f32_16x16x32_bf16 v[120:123], v[184:187], v[44:47], v[120:123]
    v_mfma_f32_16x16x32_bf16 v[124:127], v[188:191], v[44:47], v[124:127]
    v_mfma_f32_16x16x32_bf16 v[112:115], v[176:179], v[44:47], v[112:115]
    v_mfma_f32_16x16x32_bf16 v[116:119], v[180:183], v[44:47], v[116:119]
OA_CK4:
    s_waitcnt vmcnt(3)
    v_cmp_ne_u32_sdwa vcc, v51, s36 src0_sel:WORD_1 src1_sel:WORD_1
    v_and_b32 v51, 0xffff, v51
    s_cbranch_vccnz OA_RT4
OA_OK4:
    s_nop 0
    v_mfma_f32_16x16x32_bf16 v[120:123], v[200:203], v[48:51], v[120:123]
    v_mfma_f32_16x16x32_bf16 v[124:127], v[204:207], v[48:51], v[124:127]
    v_mfma_f32_16x16x32_bf16 v[112:115], v[192:195], v[48:51], v[112:115]
    v_mfma_f32_16x16x32_bf16 v[116:119], v[196:199], v[48:51], v[116:119]
OA_CK5:
    s_waitcnt vmcnt(2)
    v_cmp_ne_u32_sdwa vcc, v55, s36 src0_sel:WORD_1 src1_sel:WORD_1
    v_and_b32 v55, 0xffff, v55
    s_cbranch_vccnz OA_RT5
OA_OK5:
    s_nop 0
    v_mfma_f32_16x16x32_bf16 v[120:123], v[216:219], v[52:55], v[120:123]
    v_mfma_f32_16x16x32_bf16 v[124:127], v[220:223], v[52:55], v[124:127]
    v_mfma_f32_16x16x32_bf16 v[112:115], v[208:211], v[52:55], v[112:115]
    v_mfma_f32_16x16x32_bf16 v[116:119], v[212:215], v[52:55], v[116:119]
OA_CK6:
    s_waitcnt vmcnt(1)
    v_cmp_ne_u32_sdwa vcc, v59, s36 src0_sel:WORD_1 src1_sel:WORD_1
    v_and_b32 v59, 0xffff, v59
    s_cbranch_vccnz OA_RT6
OA_OK6:
    s_nop 0
    v_mfma_f32_16x16x32_bf16 v[120:123], v[232:235], v[56:59], v[120:123]
    v_mfma_f32_16x16x32_bf16 v[124:127], v[236:239], v[56:59], v[124:127]
    v_mfma_f32_16x16x32_bf16 v[112:115], v[224:227], v[56:59], v[112:115]
    v_mfma_f32_16x16x32_bf16 v[116:119], v[228:231], v[56:59], v[116:119]
OA_CK7:
    s_waitcnt vmcnt(0)
    v_cmp_ne_u32_sdwa vcc, v63, s36 src0_sel:WORD_1 src1_sel:WORD_1
    v_and_b32 v63, 0xffff, v63
    s_cbranch_vccnz OA_RT7
OA_OK7:
    s_nop 0
    v_mfma_f32_16x16x32_bf16 v[120:123], v[248:251], v[60:63], v[120:123]
    v_mfma_f32_16x16x32_bf16 v[124:127], v[252:255], v[60:63], v[124:127]
    v_mfma_f32_16x16x32_bf16 v[112:115], v[240:243], v[60:63], v[112:115]
    v_mfma_f32_16x16x32_bf16 v[116:119], v[244:247], v[60:63], v[116:119]
    s_nop 4
    ds_write_b128 v28, v[120:123] offset:0
    ds_write_b128 v28, v[124:127] offset:1024
    s_waitcnt lgkmcnt(0)
    s_barrier
    ds_read_b128 v[64:67], v30 offset:0
    ds_read_b128 v[68:71], v30 offset:1024
    s_waitcnt lgkmcnt(1)
    v_add_f32 v112, v112, v64
    v_add_f32 v113, v113, v65
    v_add_f32 v114, v114, v66
    v_add_f32 v115, v115, v67
    v_cvt_pk_bf16_f32 v32, v112, v113
    v_cvt_pk_bf16_f32 v33, v114, v115
    s_waitcnt lgkmcnt(0)
    v_add_f32 v116, v116, v68
    v_add_f32 v117, v117, v69
    v_add_f32 v118, v118, v70
    v_add_f32 v119, v119, v71
    v_cvt_pk_bf16_f32 v34, v116, v117
    v_cvt_pk_bf16_f32 v35, v118, v119
    s_nop 0
    v_permlane16_swap_b32 v32, v34
    v_permlane16_swap_b32 v33, v35
    buffer_store_dwordx4 v[32:35], v15, s[40:43], 0 offen sc1
A_FIN:
    s_endpgm
GA_RT0:
    s_movk_i32 s68, 0
    s_sub_u32 s67, s67, 1
    s_cmp_eq_u32 s67, 0
    s_cbranch_scc1 GA_GU0
    s_waitcnt vmcnt(0)
    s_branch GA_CH0
GA_GU0:
    s_movk_i32 s67, 1
    s_waitcnt vmcnt(0)
    s_branch GA_OK0
GA_CH0:
v_cmp_ne_u32 vcc, s36, v21
s_nop 1
s_cbranch_vccz GA_CH1
buffer_load_dwordx2 v[20:21], v29, s[32:35], 0 offen sc1
GA_CH1:
    s_waitcnt vmcnt(0)
    s_branch GA_CK0
OA_RT0:
    s_movk_i32 s68, 0
    s_sub_u32 s67, s67, 1
    s_cmp_eq_u32 s67, 0
    s_cbranch_scc1 OA_GU0
    s_waitcnt vmcnt(0)
    s_branch OA_CH0
OA_GU0:
    s_movk_i32 s67, 1
    s_waitcnt vmcnt(0)
    s_branch OA_OK0
OA_RT1:
    s_movk_i32 s68, 1
    s_sub_u32 s67, s67, 1
    s_cmp_eq_u32 s67, 0
    s_cbranch_scc1 OA_GU1
    s_waitcnt vmcnt(0)
    s_branch OA_CH1
OA_GU1:
    s_movk_i32 s67, 1
    s_waitcnt vmcnt(0)
    s_branch OA_OK1
OA_RT2:
    s_movk_i32 s68, 2
    s_sub_u32 s67, s67, 1
    s_cmp_eq_u32 s67, 0
    s_cbranch_scc1 OA_GU2
    s_waitcnt vmcnt(0)
    s_branch OA_CH2
OA_GU2:
    s_movk_i32 s67, 1
    s_waitcnt vmcnt(0)
    s_branch OA_OK2
OA_RT3:
    s_movk_i32 s68, 3
    s_sub_u32 s67, s67, 1
    s_cmp_eq_u32 s67, 0
    s_cbranch_scc1 OA_GU3
    s_waitcnt vmcnt(0)
    s_branch OA_CH3
OA_GU3:
    s_movk_i32 s67, 1
    s_waitcnt vmcnt(0)
    s_branch OA_OK3
OA_RT4:
    s_movk_i32 s68, 4
    s_sub_u32 s67, s67, 1
    s_cmp_eq_u32 s67, 0
    s_cbranch_scc1 OA_GU4
    s_waitcnt vmcnt(0)
    s_branch OA_CH4
OA_GU4:
    s_movk_i32 s67, 1
    s_waitcnt vmcnt(0)
    s_branch OA_OK4
OA_RT5:
    s_movk_i32 s68, 5
    s_sub_u32 s67, s67, 1
    s_cmp_eq_u32 s67, 0
    s_cbranch_scc1 OA_GU5
    s_waitcnt vmcnt(0)
    s_branch OA_CH5
OA_GU5:
    s_movk_i32 s67, 1
    s_waitcnt vmcnt(0)
    s_branch OA_OK5
OA_RT6:
    s_movk_i32 s68, 6
    s_sub_u32 s67, s67, 1
    s_cmp_eq_u32 s67, 0
    s_cbranch_scc1 OA_GU6
    s_waitcnt vmcnt(0)
    s_branch OA_CH6
OA_GU6:
    s_movk_i32 s67, 1
    s_waitcnt vmcnt(0)
    s_branch OA_OK6
OA_RT7:
    s_movk_i32 s68, 7
    s_sub_u32 s67, s67, 1
    s_cmp_eq_u32 s67, 0
    s_cbranch_scc1 OA_GU7
    s_waitcnt vmcnt(0)
    s_branch OA_CH7
OA_GU7:
    s_movk_i32 s67, 1
    s_waitcnt vmcnt(0)
    s_branch OA_OK7
OA_CH0:
v_cmp_ne_u32_sdwa vcc, v35, s36 src0_sel:WORD_1 src1_sel:WORD_1
s_nop 1
s_cbranch_vccz OA_CH1
buffer_load_dwordx4 v[32:35], v14, s[32:35], 0 offen sc1
OA_CH1:
v_cmp_ne_u32_sdwa vcc, v39, s36 src0_sel:WORD_1 src1_sel:WORD_1
s_nop 1
s_cbranch_vccz OA_CH2
buffer_load_dwordx4 v[36:39], v14, s[32:35], 0 offen offset:1024 sc1
OA_CH2:
v_cmp_ne_u32_sdwa vcc, v43, s36 src0_sel:WORD_1 src1_sel:WORD_1
s_nop 1
s_cbranch_vccz OA_CH3
buffer_load_dwordx4 v[40:43], v14, s[32:35], 0 offen offset:2048 sc1
OA_CH3:
v_cmp_ne_u32_sdwa vcc, v47, s36 src0_sel:WORD_1 src1_sel:WORD_1
s_nop 1
s_cbranch_vccz OA_CH4
buffer_load_dwordx4 v[44:47], v14, s[32:35], 0 offen offset:3072 sc1
OA_CH4:
v_cmp_ne_u32_sdwa vcc, v51, s36 src0_sel:WORD_1 src1_sel:WORD_1
s_nop 1
s_cbranch_vccz OA_CH5
buffer_load_dwordx4 v[48:51], v14, s[32:35], s60 offen sc1
OA_CH5:
v_cmp_ne_u32_sdwa vcc, v55, s36 src0_sel:WORD_1 src1_sel:WORD_1
s_nop 1
s_cbranch_vccz OA_CH6
buffer_load_dwordx4 v[52:55], v14, s[32:35], s60 offen offset:1024 sc1
OA_CH6:
v_cmp_ne_u32_sdwa vcc, v59, s36 src0_sel:WORD_1 src1_sel:WORD_1
s_nop 1
s_cbranch_vccz OA_CH7
buffer_load_dwordx4 v[56:59], v14, s[32:35], s60 offen offset:2048 sc1
OA_CH7:
v_cmp_ne_u32_sdwa vcc, v63, s36 src0_sel:WORD_1 src1_sel:WORD_1
s_nop 1
s_cbranch_vccz OA_CH8
buffer_load_dwordx4 v[60:63], v14, s[32:35], s60 offen offset:3072 sc1
OA_CH8:
    s_waitcnt vmcnt(0)
    s_cmp_eq_u32 s68, 0
    s_cbranch_scc1 OA_CK0
    s_cmp_eq_u32 s68, 1
    s_cbranch_scc1 OA_CK1
    s_cmp_eq_u32 s68, 2
    s_cbranch_scc1 OA_CK2
    s_cmp_eq_u32 s68, 3
    s_cbranch_scc1 OA_CK3
    s_cmp_eq_u32 s68, 4
    s_cbranch_scc1 OA_CK4
    s_cmp_eq_u32 s68, 5
    s_cbranch_scc1 OA_CK5
    s_cmp_eq_u32 s68, 6
    s_cbranch_scc1 OA_CK6
    s_branch OA_CK7
B_START:
    s_mov_b32 s30, 896
    s_mov_b32 s31, 0x20000
    s_mul_i32 s60, s8, 14
    v_add_u32 v4, s60, v1
    v_lshrrev_b32 v5, 3, v4
    v_add_u32 v5, s11, v5
    v_subrev_u32 v8, 7, v5
    v_cmp_lt_u32 vcc, 6, v5
    s_nop 1
    v_cndmask_b32 v5, v5, v8, vcc
    v_and_b32 v8, 7, v4
    v_lshlrev_b32 v8, 4, v8
    v_lshl_add_u32 v121, v5, 7, v8
    s_mov_b32 s37, 5246976
    s_waitcnt lgkmcnt(0)
    s_load_dword s36, s[32:33], s37
    v_lshrrev_b32 v5, 1, v4
    v_and_b32 v8, 1, v4
    v_lshlrev_b32 v8, 9, v8
    v_lshl_add_u32 v120, v5, 10, v8
    v_add_u32 v120, 110816, v120
    s_add_u32 s62, s62, 1
    s_cmp_eq_u32 s62, 7
    s_cselect_b32 s62, 0, s62
    s_lshl_b32 s46, s62, 7
    s_mul_i32 s53, s62, 172032
    s_add_u32 s62, s62, 1
    s_cmp_eq_u32 s62, 7
    s_cselect_b32 s62, 0, s62
    s_lshl_b32 s47, s62, 7
    s_mul_i32 s54, s62, 172032
    s_add_u32 s62, s62, 1
    s_cmp_eq_u32 s62, 7
    s_cselect_b32 s62, 0, s62
    s_lshl_b32 s48, s62, 7
    s_mul_i32 s55, s62, 172032
    s_add_u32 s62, s62, 1
    s_cmp_eq_u32 s62, 7
    s_cselect_b32 s62, 0, s62
    s_lshl_b32 s49, s62, 7
    s_mul_i32 s56, s62, 172032
    s_add_u32 s62, s62, 1
    s_cmp_eq_u32 s62, 7
    s_cselect_b32 s62, 0, s62
    s_lshl_b32 s50, s62, 7
    s_mul_i32 s57, s62, 172032
    s_mov_b32 s22, 25088
    s_mov_b32 s23, 0x20000
    s_mov_b32 s26, 401408
    s_mov_b32 s27, 0x20000
    s_mov_b32 s34, 7340032
    s_mov_b32 s35, 0x20000
    s_mov_b32 s42, 1835008
    s_mov_b32 s43, 0x20000
    v_lshlrev_b32 v3, 4, v1
    v_and_b32 v6, 31, v1
    v_lshrrev_b32 v7, 5, v1
    v_bfe_u32 v8, v1, 1, 3
    v_xor_b32 v8, v8, v7
    v_lshlrev_b32 v8, 4, v8
    v_lshl_add_u32 v16, v6, 7, v8
    s_lshl_b32 s60, s8, 12
    v_add_u32 v16, s60, v16
    v_xor_b32 v17, 32, v16
    v_xor_b32 v18, 64, v16
    v_xor_b32 v19, 0x60, v16
    v_bfe_u32 v8, v1, 4, 1
    v_and_b32 v9, 3, v1
    v_lshl_add_u32 v8, v8, 2, v9
    v_cmp_lt_u32 vcc, 5, v8
    s_nop 1
    v_cndmask_b32 v8, v8, 7, vcc
    v_lshlrev_b32 v8, 3, v8
    v_bfe_u32 v9, v1, 2, 2
    v_lshl_add_u32 v8, v9, 6, v8
    v_lshl_add_u32 v20, v7, 9, v8
    s_mov_b32 s68, 1069066811
    s_mov_b32 s69, 3216550459
    s_mov_b64 exec, 0x3fff
    buffer_load_dwordx4 v[116:119], v121, s[28:31], 0 offen
    s_mov_b64 exec, -1
    s_add_u32 m0, s58, 0
    s_nop 0
    buffer_load_dwordx4 v11, s[12:15], s44 offen lds
    buffer_load_dwordx4 v12, s[12:15], s44 offen offset:1024 lds
    v_lshrrev_b32 v4, 2, v1
    v_and_b32 v5, 3, v1
    v_lshlrev_b32 v5, 4, v5
    v_min_u32 v5, 40, v5
    s_movk_i32 s63, 2688
    v_mad_u32_u24 v10, v4, s63, v5
    s_mul_i32 s60, s8, 43008
    s_mul_i32 s61, s5, 56
    s_add_u32 s60, s60, s61
    s_add_u32 s60, s60, 896
    v_add_u32 v10, s60, v10
    s_lshl_b32 s59, s8, 10
    v_add_u32 v21, 32768, v20
    v_add_u32 v20, 143360, v20
    v_add_u32 v15, 896, v10
    s_sub_u32 s60, s6, s5
    s_mul_i32 s60, s60, 56
    s_sub_u32 s60, s60, 896
    v_add_u32 v14, s60, v10
    v_subrev_u32 v28, 917504, v11
    v_subrev_u32 v29, 917504, v12
    v_add_u32 v22, 110592, v3
    v_and_b32 v4, 15, v1
    v_min_u32 v5, 13, v4
    s_mul_i32 s60, s5, 14
    v_add_u32 v5, s60, v5
    v_cmp_eq_u32 vcc, 15, v4
    v_mov_b32 v8, 224
    s_nop 0
    v_cndmask_b32 v5, v5, v8, vcc
    v_cvt_f32_u32 v5, v5
    v_mul_f32 v124, 0x3b124925, v5
    v_bfe_u32 v4, v1, 4, 1
    v_cvt_f32_u32 v4, v4
    v_mul_f32 v4, 0x3e800000, v4
    s_lshl_b32 s60, s8, 4
    v_lshl_add_u32 v5, v7, 3, s60
    v_cvt_f32_u32 v5, v5
    v_fma_f32 v125, v5, v124, v4
    s_lshl_b32 s60, s8, 10
    v_add_u32 v126, s60, v22
    v_cos_f32 v123, v124
    s_nop 0
    v_add_f32 v123, v123, v123
    v_add_u32 v24, 0x10000, v16
    v_add_u32 v25, 0x10000, v17
    v_add_u32 v26, 0x10000, v18
    v_add_u32 v27, 0x10000, v19
    s_lshr_b32 s60, s44, 1
    v_cvt_f32_u32 v4, s60
    v_fma_f32 v4, v4, v124, v125
    v_add_f32 v5, v4, v124
    v_cos_f32 v4, v4
    v_cos_f32 v5, v5
    s_nop 0
    v_fma_f32 v8, v123, v5, -v4
    v_cvt_pk_bf16_f32 v240, v4, v5
    v_fma_f32 v9, v123, v8, -v5
    v_fma_f32 v4, v123, v9, -v8
    v_cvt_pk_bf16_f32 v241, v8, v9
    v_fma_f32 v5, v123, v4, -v9
    v_fma_f32 v8, v123, v5, -v4
    v_cvt_pk_bf16_f32 v242, v4, v5
    v_fma_f32 v9, v123, v8, -v5
    v_cvt_pk_bf16_f32 v243, v8, v9
    s_mov_b32 exec_lo, 0xffffbfff
    s_mov_b32 exec_hi, 0xffffbfff
    ds_write_b128 v126, v[240:243] offset:0
    s_mov_b64 exec, -1
    s_lshr_b32 s60, s45, 1
    v_cvt_f32_u32 v4, s60
    v_fma_f32 v4, v4, v124, v125
    v_add_f32 v5, v4, v124
    v_cos_f32 v4, v4
    v_cos_f32 v5, v5
    s_nop 0
    v_fma_f32 v8, v123, v5, -v4
    v_cvt_pk_bf16_f32 v244, v4, v5
    v_fma_f32 v9, v123, v8, -v5
    v_fma_f32 v4, v123, v9, -v8
    v_cvt_pk_bf16_f32 v245, v8, v9
    v_fma_f32 v5, v123, v4, -v9
    v_fma_f32 v8, v123, v5, -v4
    v_cvt_pk_bf16_f32 v246, v4, v5
    v_fma_f32 v9, v123, v8, -v5
    v_cvt_pk_bf16_f32 v247, v8, v9
    s_mov_b32 exec_lo, 0xffffbfff
    s_mov_b32 exec_hi, 0xffffbfff
    ds_write_b128 v126, v[244:247] offset:4096
    s_mov_b64 exec, -1
    s_lshr_b32 s60, s46, 1
    v_cvt_f32_u32 v4, s60
    v_fma_f32 v4, v4, v124, v125
    v_add_f32 v5, v4, v124
    v_cos_f32 v4, v4
    v_cos_f32 v5, v5
    s_nop 0
    v_fma_f32 v8, v123, v5, -v4
    v_cvt_pk_bf16_f32 v240, v4, v5
    v_fma_f32 v9, v123, v8, -v5
    v_fma_f32 v4, v123, v9, -v8
    v_cvt_pk_bf16_f32 v241, v8, v9
    v_fma_f32 v5, v123, v4, -v9
    v_fma_f32 v8, v123, v5, -v4
    v_cvt_pk_bf16_f32 v242, v4, v5
    v_fma_f32 v9, v123, v8, -v5
    v_cvt_pk_bf16_f32 v243, v8, v9
    s_mov_b32 exec_lo, 0xffffbfff
    s_mov_b32 exec_hi, 0xffffbfff
    ds_write_b128 v126, v[240:243] offset:8192
    s_mov_b64 exec, -1
    s_lshr_b32 s60, s47, 1
    v_cvt_f32_u32 v4, s60
    v_fma_f32 v4, v4, v124, v125
    v_add_f32 v5, v4, v124
    v_cos_f32 v4, v4
    v_cos_f32 v5, v5
    s_nop 0
    v_fma_f32 v8, v123, v5, -v4
    v_cvt_pk_bf16_f32 v244, v4, v5
    v_fma_f32 v9, v123, v8, -v5
    v_fma_f32 v4, v123, v9, -v8
    v_cvt_pk_bf16_f32 v245, v8, v9
    v_fma_f32 v5, v123, v4, -v9
    v_fma_f32 v8, v123, v5, -v4
    v_cvt_pk_bf16_f32 v246, v4, v5
    v_fma_f32 v9, v123, v8, -v5
    v_cvt_pk_bf16_f32 v247, v8, v9
    s_mov_b32 exec_lo, 0xffffbfff
    s_mov_b32 exec_hi, 0xffffbfff
    ds_write_b128 v126, v[244:247] offset:12288
    s_mov_b64 exec, -1
    s_lshr_b32 s60, s48, 1
    v_cvt_f32_u32 v4, s60
    v_fma_f32 v4, v4, v124, v125
    v_add_f32 v5, v4, v124
    v_cos_f32 v4, v4
    v_cos_f32 v5, v5
    s_nop 0
    v_fma_f32 v8, v123, v5, -v4
    v_cvt_pk_bf16_f32 v240, v4, v5
    v_fma_f32 v9, v123, v8, -v5
    v_fma_f32 v4, v123, v9, -v8
    v_cvt_pk_bf16_f32 v241, v8, v9
    v_fma_f32 v5, v123, v4, -v9
    v_fma_f32 v8, v123, v5, -v4
    v_cvt_pk_bf16_f32 v242, v4, v5
    v_fma_f32 v9, v123, v8, -v5
    v_cvt_pk_bf16_f32 v243, v8, v9
    s_mov_b32 exec_lo, 0xffffbfff
    s_mov_b32 exec_hi, 0xffffbfff
    ds_write_b128 v126, v[240:243] offset:16384
    s_mov_b64 exec, -1
    s_lshr_b32 s60, s49, 1
    v_cvt_f32_u32 v4, s60
    v_fma_f32 v4, v4, v124, v125
    v_add_f32 v5, v4, v124
    v_cos_f32 v4, v4
    v_cos_f32 v5, v5
    s_nop 0
    v_fma_f32 v8, v123, v5, -v4
    v_cvt_pk_bf16_f32 v244, v4, v5
    v_fma_f32 v9, v123, v8, -v5
    v_fma_f32 v4, v123, v9, -v8
    v_cvt_pk_bf16_f32 v245, v8, v9
    v_fma_f32 v5, v123, v4, -v9
    v_fma_f32 v8, v123, v5, -v4
    v_cvt_pk_bf16_f32 v246, v4, v5
    v_fma_f32 v9, v123, v8, -v5
    v_cvt_pk_bf16_f32 v247, v8, v9
    s_mov_b32 exec_lo, 0xffffbfff
    s_mov_b32 exec_hi, 0xffffbfff
    ds_write_b128 v126, v[244:247] offset:20480
    s_mov_b64 exec, -1
    s_lshr_b32 s60, s50, 1
    v_cvt_f32_u32 v4, s60
    v_fma_f32 v4, v4, v124, v125
    v_add_f32 v5, v4, v124
    v_cos_f32 v4, v4
    v_cos_f32 v5, v5
    s_nop 0
    v_fma_f32 v8, v123, v5, -v4
    v_cvt_pk_bf16_f32 v240, v4, v5
    v_fma_f32 v9, v123, v8, -v5
    v_fma_f32 v4, v123, v9, -v8
    v_cvt_pk_bf16_f32 v241, v8, v9
    v_fma_f32 v5, v123, v4, -v9
    v_fma_f32 v8, v123, v5, -v4
    v_cvt_pk_bf16_f32 v242, v4, v5
    v_fma_f32 v9, v123, v8, -v5
    v_cvt_pk_bf16_f32 v243, v8, v9
    s_mov_b32 exec_lo, 0xffffbfff
    s_mov_b32 exec_hi, 0xffffbfff
    ds_write_b128 v126, v[240:243] offset:24576
    s_mov_b64 exec, -1
    s_waitcnt vmcnt(2)
    s_mov_b64 exec, 0x3fff
    ds_write_b128 v120, v[116:119]
    s_mov_b64 exec, -1
    s_waitcnt lgkmcnt(0)
    s_lshr_b32 s36, s36, 16
    s_add_u32 s36, s36, 1
    s_and_b32 s36, s36, 0x9fff
    s_or_b32 s36, s36, 0x2000
    s_lshl_b32 s30, s36, 16
    s_or_b32 s36, s36, s30
    s_waitcnt vmcnt(0)
    s_barrier
    ds_read_b128 v[128:131], v16 offset:0
    ds_read_b128 v[32:35], v22 offset:0
    ds_read_b128 v[132:135], v17 offset:0
    ds_read_b128 v[36:39], v22 offset:1024
    ds_read_b128 v[136:139], v18 offset:0
    ds_read_b128 v[40:43], v22 offset:2048
    ds_read_b128 v[140:143], v19 offset:0
    ds_read_b128 v[44:47], v22 offset:3072
    s_add_u32 m0, s58, 49152
    s_nop 0
    buffer_load_dwordx4 v11, s[12:15], s47 offen lds
    buffer_load_dwordx4 v12, s[12:15], s47 offen offset:1024 lds
    s_barrier
    s_waitcnt lgkmcnt(6)
    v_mfma_f32_32x32x16_bf16 v[64:79], v[128:131], v[32:35], 0
    ds_read_b128 v[144:147], v16 offset:16384
    ds_read_b128 v[48:51], v22 offset:4096
    s_waitcnt lgkmcnt(6)
    v_mfma_f32_32x32x16_bf16 v[64:79], v[132:135], v[36:39], v[64:79]
    ds_read_b128 v[148:151], v17 offset:16384
    ds_read_b128 v[52:55], v22 offset:5120
    s_add_u32 m0, s58, 65536
    s_nop 0
    buffer_load_dwordx4 v11, s[12:15], s48 offen lds
    s_waitcnt lgkmcnt(6)
    v_mfma_f32_32x32x16_bf16 v[64:79], v[136:139], v[40:43], v[64:79]
    ds_read_b128 v[152:155], v18 offset:16384
    ds_read_b128 v[56:59], v22 offset:6144
    s_waitcnt lgkmcnt(6)
    v_mfma_f32_32x32x16_bf16 v[64:79], v[140:143], v[44:47], v[64:79]
    ds_read_b128 v[156:159], v19 offset:16384
    ds_read_b128 v[60:63], v22 offset:7168
    buffer_load_dwordx4 v12, s[12:15], s48 offen offset:1024 lds
    s_barrier
    s_waitcnt lgkmcnt(6)
    v_mfma_f32_32x32x16_bf16 v[64:79], v[144:147], v[48:51], v[64:79]
    ds_read_b128 v[160:163], v16 offset:32768
    ds_read_b128 v[32:35], v22 offset:8192
    v_lshrrev_b32 v4, 1, v6
    v_cvt_f32_u32 v122, v4
    v_mul_f32 v122, 0x3d000000, v122
    v_and_b32 v5, 1, v6
    v_cvt_f32_u32 v5, v5
    v_mul_f32 v5, 0x3e800000, v5
    v_cvt_f32_u32 v8, v7
    v_mul_f32 v8, 4.0, v8
    v_fma_f32 v127, v122, v8, v5
    v_and_b32 v4, 1, v4
    v_mul_u32_u24 v2, 0x8000, v4
    v_lshl_or_b32 v2, v2, 16, v2
    v_fmamk_f32 v8, v122, 0x00000000, v127
    v_fmamk_f32 v9, v122, 0x3f800000, v127
    v_cos_f32 v4, v8
    v_cos_f32 v5, v9
    v_sin_f32 v8, v8
    v_sin_f32 v9, v9
    v_cvt_pk_bf16_f32 v96, v4, v5
    v_cvt_pk_bf16_f32 v104, v8, v9
    v_xor_b32 v100, v2, v96
    v_xor_b32 v108, v2, v104
    s_waitcnt lgkmcnt(6)
    v_mfma_f32_32x32x16_bf16 v[64:79], v[148:151], v[52:55], v[64:79]
    ds_read_b128 v[164:167], v17 offset:32768
    ds_read_b128 v[36:39], v22 offset:9216
    s_add_u32 m0, s58, 0
    s_nop 0
    buffer_load_dwordx4 v11, s[12:15], s49 offen lds
    s_waitcnt lgkmcnt(6)
    v_mfma_f32_32x32x16_bf16 v[64:79], v[152:155], v[56:59], v[64:79]
    ds_read_b128 v[168:171], v18 offset:32768
    ds_read_b128 v[40:43], v22 offset:10240
    s_waitcnt lgkmcnt(6)
    v_mfma_f32_32x32x16_bf16 v[64:79], v[156:159], v[60:63], v[64:79]
    ds_read_b128 v[172:175], v19 offset:32768
    ds_read_b128 v[44:47], v22 offset:11264
    buffer_load_dwordx4 v12, s[12:15], s49 offen offset:1024 lds
    s_waitcnt vmcnt(4)
    s_barrier
    s_waitcnt lgkmcnt(6)
    v_mfma_f32_32x32x16_bf16 v[64:79], v[160:163], v[32:35], v[64:79]
    ds_read_b128 v[176:179], v16 offset:49152
    ds_read_b128 v[48:51], v22 offset:12288
    v_fmamk_f32 v8, v122, 0x40000000, v127
    v_fmamk_f32 v9, v122, 0x40400000, v127
    v_cos_f32 v4, v8
    v_cos_f32 v5, v9
    v_sin_f32 v8, v8
    v_sin_f32 v9, v9
    v_cvt_pk_bf16_f32 v97, v4, v5
    v_cvt_pk_bf16_f32 v105, v8, v9
    v_xor_b32 v101, v2, v97
    v_xor_b32 v109, v2, v105
    s_waitcnt lgkmcnt(6)
    v_mfma_f32_32x32x16_bf16 v[64:79], v[164:167], v[36:39], v[64:79]
    ds_read_b128 v[180:183], v17 offset:49152
    ds_read_b128 v[52:55], v22 offset:13312
    s_add_u32 m0, s58, 16384
    s_nop 0
    buffer_load_dwordx4 v11, s[12:15], s50 offen lds
    s_waitcnt lgkmcnt(6)
    v_mfma_f32_32x32x16_bf16 v[64:79], v[168:171], v[40:43], v[64:79]
    ds_read_b128 v[184:187], v18 offset:49152
    ds_read_b128 v[56:59], v22 offset:14336
    s_waitcnt lgkmcnt(6)
    v_mfma_f32_32x32x16_bf16 v[64:79], v[172:175], v[44:47], v[64:79]
    ds_read_b128 v[188:191], v19 offset:49152
    ds_read_b128 v[60:63], v22 offset:15360
    buffer_load_dwordx4 v12, s[12:15], s50 offen offset:1024 lds
    s_waitcnt vmcnt(4)
    s_barrier
    s_waitcnt lgkmcnt(6)
    v_mfma_f32_32x32x16_bf16 v[64:79], v[176:179], v[48:51], v[64:79]
    ds_read_b128 v[192:195], v24
    ds_read_b128 v[32:35], v22 offset:16384
    v_fmamk_f32 v8, v122, 0x41000000, v127
    v_fmamk_f32 v9, v122, 0x41100000, v127
    v_cos_f32 v4, v8
    v_cos_f32 v5, v9
    v_sin_f32 v8, v8
    v_sin_f32 v9, v9
    v_cvt_pk_bf16_f32 v98, v4, v5
    v_cvt_pk_bf16_f32 v106, v8, v9
    v_xor_b32 v102, v2, v98
    v_xor_b32 v110, v2, v106
    s_waitcnt lgkmcnt(6)
    v_mfma_f32_32x32x16_bf16 v[64:79], v[180:183], v[52:55], v[64:79]
    ds_read_b128 v[196:199], v25
    ds_read_b128 v[36:39], v22 offset:17408
    s_add_u32 m0, s59, 151552
    s_nop 0
    buffer_load_dwordx4 v15, s[16:19], s53 offen lds
    s_waitcnt lgkmcnt(6)
    v_mfma_f32_32x32x16_bf16 v[64:79], v[184:187], v[56:59], v[64:79]
    ds_read_b128 v[200:203], v26
    ds_read_b128 v[40:43], v22 offset:18432
    s_waitcnt lgkmcnt(6)
    v_mfma_f32_32x32x16_bf16 v[64:79], v[188:191], v[60:63], v[64:79]
    ds_read_b128 v[204:207], v27
    ds_read_b128 v[44:47], v22 offset:19456
    s_add_u32 m0, s59, 155648
    s_nop 0
    buffer_load_dwordx4 v15, s[16:19], s54 offen lds
    s_waitcnt vmcnt(4)
    s_barrier
    s_waitcnt lgkmcnt(6)
    v_mfma_f32_32x32x16_bf16 v[64:79], v[192:195], v[32:35], v[64:79]
    ds_read_b128 v[208:211], v16 offset:0
    ds_read_b128 v[48:51], v22 offset:20480
    v_fmamk_f32 v8, v122, 0x41200000, v127
    v_fmamk_f32 v9, v122, 0x41300000, v127
    v_cos_f32 v4, v8
    v_cos_f32 v5, v9
    v_sin_f32 v8, v8
    v_sin_f32 v9, v9
    v_cvt_pk_bf16_f32 v99, v4, v5
    v_cvt_pk_bf16_f32 v107, v8, v9
    v_xor_b32 v103, v2, v99
    v_xor_b32 v111, v2, v107
    s_waitcnt lgkmcnt(6)
    v_mfma_f32_32x32x16_bf16 v[64:79], v[196:199], v[36:39], v[64:79]
    ds_read_b128 v[212:215], v17 offset:0
    ds_read_b128 v[52:55], v22 offset:21504
    s_add_u32 m0, s59, 32768
    s_nop 0
    buffer_load_dwordx4 v15, s[16:19], s56 offen lds
    s_waitcnt lgkmcnt(6)
    v_mfma_f32_32x32x16_bf16 v[64:79], v[200:203], v[40:43], v[64:79]
    ds_read_b128 v[216:219], v18 offset:0
    ds_read_b128 v[56:59], v22 offset:22528
    s_waitcnt lgkmcnt(6)
    v_mfma_f32_32x32x16_bf16 v[64:79], v[204:207], v[44:47], v[64:79]
    ds_read_b128 v[220:223], v19 offset:0
    ds_read_b128 v[60:63], v22 offset:23552
    s_add_u32 m0, s59, 36864
    s_nop 0
    buffer_load_dwordx4 v15, s[16:19], s57 offen lds
    s_waitcnt vmcnt(4)
    s_barrier
    s_waitcnt lgkmcnt(6)
    v_mfma_f32_32x32x16_bf16 v[64:79], v[208:211], v[48:51], v[64:79]
    ds_read_b128 v[224:227], v16 offset:16384
    ds_read_b128 v[32:35], v22 offset:24576
    v_bfe_u32 v4, v1, 1, 2
    v_xor_b32 v4, v4, v7
    v_lshlrev_b32 v4, 4, v4
    v_lshl_add_u32 v4, v6, 6, v4
    s_lshl_b32 s60, s8, 11
    s_add_u32 s60, s60, 16384
    v_add_u32 v30, s60, v4
    v_xor_b32 v31, 32, v30
    s_lshl_b32 s60, s6, 2
    s_add_u32 s60, s60, s8
    s_lshl_b32 s60, s60, 14
    s_add_u32 s60, s60, 4194304
    v_add_u32 v13, s60, v3
    s_waitcnt lgkmcnt(6)
    v_mfma_f32_32x32x16_bf16 v[64:79], v[212:215], v[52:55], v[64:79]
    ds_read_b128 v[228:231], v17 offset:16384
    ds_read_b128 v[36:39], v22 offset:25600
    s_waitcnt lgkmcnt(6)
    v_mfma_f32_32x32x16_bf16 v[64:79], v[216:219], v[56:59], v[64:79]
    ds_read_b128 v[232:235], v18 offset:16384
    ds_read_b128 v[40:43], v22 offset:26624
    s_waitcnt lgkmcnt(6)
    v_mfma_f32_32x32x16_bf16 v[64:79], v[220:223], v[60:63], v[64:79]
    ds_read_b128 v[236:239], v19 offset:16384
    ds_read_b128 v[44:47], v22 offset:27648
    s_waitcnt lgkmcnt(6)
    v_mfma_f32_32x32x16_bf16 v[64:79], v[224:227], v[32:35], v[64:79]
    s_waitcnt lgkmcnt(4)
    v_mfma_f32_32x32x16_bf16 v[64:79], v[228:231], v[36:39], v[64:79]
    s_waitcnt lgkmcnt(2)
    v_mfma_f32_32x32x16_bf16 v[64:79], v[232:235], v[40:43], v[64:79]
    s_waitcnt lgkmcnt(0)
    v_mfma_f32_32x32x16_bf16 v[64:79], v[236:239], v[44:47], v[64:79]
    s_waitcnt vmcnt(2)
    s_barrier
    s_setprio 3
    ds_read_b64_tr_b16 v[32:33], v20 offset:0
    ds_read_b64_tr_b16 v[34:35], v20 offset:256
    ds_read_b64_tr_b16 v[36:37], v20 offset:1024
    ds_read_b64_tr_b16 v[38:39], v20 offset:1280
    ds_read_b64_tr_b16 v[40:41], v20 offset:2048
    ds_read_b64_tr_b16 v[42:43], v20 offset:2304
    ds_read_b64_tr_b16 v[44:45], v20 offset:3072
    ds_read_b64_tr_b16 v[46:47], v20 offset:3328
    s_waitcnt lgkmcnt(6)
    v_mfma_f32_32x32x16_bf16 v[80:95], v[32:35], v[128:131], 0
    ds_read_b64_tr_b16 v[48:49], v20 offset:4096
    ds_read_b64_tr_b16 v[50:51], v20 offset:4352
    v_lshlrev_b32 v4, 4, v7
    s_lshl_b32 s60, s8, 7
    s_add_u32 s60, s60, 77824
    v_add_u32 v10, s60, v4
    s_lshl_b32 s60, s8, 2
    s_waitcnt lgkmcnt(6)
    v_mfma_f32_32x32x16_bf16 v[80:95], v[36:39], v[132:135], v[80:95]
    ds_read_b64_tr_b16 v[52:53], v20 offset:5120
    ds_read_b64_tr_b16 v[54:55], v20 offset:5376
    s_add_u32 s60, s60, 40960
    v_add_u32 v11, s60, v3
    s_mov_b32 exec_lo, 0x4000
    s_mov_b32 exec_hi, 0x4000
    ds_write_b128 v10, v[64:67] offset:0
    ds_write_b128 v10, v[68:71] offset:32
    ds_write_b128 v10, v[72:75] offset:64
    ds_write_b128 v10, v[76:79] offset:96
    s_mov_b64 exec, -1
    v_cvt_pk_bf16_f32 v240, v64, v65
    s_waitcnt lgkmcnt(10)
    v_mfma_f32_32x32x16_bf16 v[80:95], v[40:43], v[136:139], v[80:95]
    ds_read_b64_tr_b16 v[56:57], v20 offset:6144
    ds_read_b64_tr_b16 v[58:59], v20 offset:6400
    v_cvt_pk_bf16_f32 v241, v66, v67
    v_cvt_pk_bf16_f32 v242, v68, v69
    v_cvt_pk_bf16_f32 v243, v70, v71
    v_cvt_pk_bf16_f32 v244, v72, v73
    s_waitcnt lgkmcnt(10)
    v_mfma_f32_32x32x16_bf16 v[80:95], v[44:47], v[140:143], v[80:95]
    ds_read_b64_tr_b16 v[60:61], v20 offset:7168
    ds_read_b64_tr_b16 v[62:63], v20 offset:7424
    v_cvt_pk_bf16_f32 v245, v74, v75
    v_cvt_pk_bf16_f32 v246, v76, v77
    v_cvt_pk_bf16_f32 v247, v78, v79
    v_xor_b32 v248, 0x80000000, v240
    s_waitcnt lgkmcnt(10)
    v_mfma_f32_32x32x16_bf16 v[80:95], v[48:51], v[144:147], v[80:95]
    ds_read_b64_tr_b16 v[32:33], v20 offset:8192
    ds_read_b64_tr_b16 v[34:35], v20 offset:8448
    v_xor_b32 v249, 0x80000000, v241
    v_xor_b32 v250, 0x80000000, v242
    v_xor_b32 v251, 0x80000000, v243
    v_xor_b32 v252, 0x80000000, v244
    s_waitcnt lgkmcnt(10)
    v_mfma_f32_32x32x16_bf16 v[80:95], v[52:55], v[148:151], v[80:95]
    ds_read_b64_tr_b16 v[36:37], v20 offset:9216
    ds_read_b64_tr_b16 v[38:39], v20 offset:9472
    v_xor_b32 v253, 0x80000000, v245
    v_xor_b32 v254, 0x80000000, v246
    v_xor_b32 v255, 0x80000000, v247
    v_permlane16_swap_b32 v240, v248
    s_waitcnt lgkmcnt(6)
    v_mfma_f32_32x32x16_bf16 v[80:95], v[56:59], v[152:155], v[80:95]
    ds_read_b64_tr_b16 v[40:41], v20 offset:10240
    ds_read_b64_tr_b16 v[42:43], v20 offset:10496
    v_permlane16_swap_b32 v241, v249
    v_permlane16_swap_b32 v242, v250
    v_permlane16_swap_b32 v243, v251
    v_permlane16_swap_b32 v244, v252
    s_waitcnt lgkmcnt(6)
    v_mfma_f32_32x32x16_bf16 v[80:95], v[60:63], v[156:159], v[80:95]
    ds_read_b64_tr_b16 v[44:45], v20 offset:11264
    ds_read_b64_tr_b16 v[46:47], v20 offset:11520
    v_permlane16_swap_b32 v245, v253
    v_permlane16_swap_b32 v246, v254
    v_permlane16_swap_b32 v247, v255
    v_mfma_f32_32x32x16_bf16 v[64:79], v[96:99], v[240:243], 0
    s_nop 0
    v_mfma_f32_32x32x16_bf16 v[64:79], v[100:103], v[244:247], v[64:79]
    v_mfma_f32_32x32x16_bf16 v[64:79], v[104:107], v[248:251], v[64:79]
    v_mfma_f32_32x32x16_bf16 v[64:79], v[108:111], v[252:255], v[64:79]
    s_waitcnt lgkmcnt(6)
    v_mfma_f32_32x32x16_bf16 v[80:95], v[32:35], v[160:163], v[80:95]
    ds_read_b64_tr_b16 v[48:49], v20 offset:12288
    ds_read_b64_tr_b16 v[50:51], v20 offset:12544
    s_lshr_b32 s60, s2, 3
    s_lshl_b32 s60, s60, 2
    s_add_u32 s60, s60, s8
    s_mul_i32 s60, s60, 3200
    v_lshlrev_b32 v126, 7, v1
    s_mov_b32 exec_hi, 0
    s_mov_b32 exec_lo, 0x1ffffff
    buffer_load_dword v126, v126, s[24:27], s60 offen
    s_mov_b64 exec, -1
    v_and_b32 v9, 15, v1
    v_lshlrev_b32 v8, 4, v9
    v_bfe_u32 v9, v1, 4, 1
    s_waitcnt lgkmcnt(6)
    v_mfma_f32_32x32x16_bf16 v[80:95], v[36:39], v[164:167], v[80:95]
    ds_read_b64_tr_b16 v[52:53], v20 offset:13312
    ds_read_b64_tr_b16 v[54:55], v20 offset:13568
    v_lshl_add_u32 v8, v9, 20, v8
    v_lshl_add_u32 v8, v7, 17, v8
    s_lshl_b32 s44, s8, 18
    s_lshl_b32 s45, s4, 12
    s_waitcnt lgkmcnt(6)
    v_mfma_f32_32x32x16_bf16 v[80:95], v[40:43], v[168:171], v[80:95]
    ds_read_b64_tr_b16 v[56:57], v20 offset:14336
    ds_read_b64_tr_b16 v[58:59], v20 offset:14592
    s_add_u32 s44, s44, s45
    s_lshl_b32 s45, s5, 8
    s_add_u32 s44, s44, s45
    s_add_u32 s44, s44, 2097152
    s_waitcnt lgkmcnt(6)
    v_mfma_f32_32x32x16_bf16 v[80:95], v[44:47], v[172:175], v[80:95]
    ds_read_b64_tr_b16 v[60:61], v20 offset:15360
    ds_read_b64_tr_b16 v[62:63], v20 offset:15616
    s_add_u32 s45, s44, 65536
    s_lshl_b32 s60, s8, 11
    s_add_u32 s60, s60, 40960
    v_add_u32 v12, s60, v3
    s_waitcnt lgkmcnt(6)
    v_mfma_f32_32x32x16_bf16 v[80:95], v[48:51], v[176:179], v[80:95]
    v_cvt_pk_bf16_f32 v240, v64, v65
    ds_write_b32 v11, v240 offset:0
    v_cvt_pk_bf16_f32 v241, v66, v67
    ds_write_b32 v11, v241 offset:1024
    s_waitcnt lgkmcnt(6)
    v_mfma_f32_32x32x16_bf16 v[80:95], v[52:55], v[180:183], v[80:95]
    v_cvt_pk_bf16_f32 v242, v68, v69
    ds_write_b32 v11, v242 offset:2048
    v_cvt_pk_bf16_f32 v243, v70, v71
    ds_write_b32 v11, v243 offset:3072
    s_waitcnt lgkmcnt(6)
    v_mfma_f32_32x32x16_bf16 v[80:95], v[56:59], v[184:187], v[80:95]
    v_cvt_pk_bf16_f32 v244, v72, v73
    ds_write_b32 v11, v244 offset:4096
    v_cvt_pk_bf16_f32 v245, v74, v75
    ds_write_b32 v11, v245 offset:5120
    s_waitcnt lgkmcnt(6)
    v_mfma_f32_32x32x16_bf16 v[80:95], v[60:63], v[188:191], v[80:95]
    v_cvt_pk_bf16_f32 v246, v76, v77
    ds_write_b32 v11, v246 offset:6144
    v_cvt_pk_bf16_f32 v247, v78, v79
    ds_write_b32 v11, v247 offset:7168
    s_waitcnt vmcnt(1)
    s_waitcnt lgkmcnt(0)
    s_barrier
    ds_read_b64_tr_b16 v[32:33], v20 offset:16384
    ds_read_b64_tr_b16 v[34:35], v20 offset:16640
    ds_read_b64_tr_b16 v[36:37], v20 offset:17408
    ds_read_b64_tr_b16 v[38:39], v20 offset:17664
    ds_read_b64_tr_b16 v[40:41], v20 offset:18432
    ds_read_b64_tr_b16 v[42:43], v20 offset:18688
    ds_read_b64_tr_b16 v[44:45], v20 offset:19456
    ds_read_b64_tr_b16 v[46:47], v20 offset:19712
    ds_read_b128 v[248:251], v12
    ds_read_b128 v[252:255], v12 offset:1024
    s_waitcnt lgkmcnt(8)
    v_mfma_f32_32x32x16_bf16 v[80:95], v[32:35], v[192:195], v[80:95]
    ds_read_b64_tr_b16 v[48:49], v21 offset:0
    ds_read_b64_tr_b16 v[50:51], v21 offset:256
    s_waitcnt lgkmcnt(8)
    v_mfma_f32_32x32x16_bf16 v[80:95], v[36:39], v[196:199], v[80:95]
    ds_read_b64_tr_b16 v[52:53], v21 offset:1024
    ds_read_b64_tr_b16 v[54:55], v21 offset:1280
    s_waitcnt lgkmcnt(4)
    buffer_store_dwordx4 v[248:251], v8, s[32:35], s44 offen sc1
    buffer_store_dwordx4 v[252:255], v8, s[32:35], s45 offen sc1
    v_mfma_f32_32x32x16_bf16 v[80:95], v[40:43], v[200:203], v[80:95]
    ds_read_b64_tr_b16 v[56:57], v21 offset:2048
    ds_read_b64_tr_b16 v[58:59], v21 offset:2304
    s_add_u32 m0, s59, 57344
    s_nop 0
    buffer_load_dwordx4 v14, s[16:19], s53 offen lds
    v_mfma_f32_32x32x16_bf16 v[80:95], v[44:47], v[204:207], v[80:95]
    ds_read_b64_tr_b16 v[60:61], v21 offset:3072
    ds_read_b64_tr_b16 v[62:63], v21 offset:3328
    s_add_u32 m0, s59, 61440
    s_nop 0
    buffer_load_dwordx4 v14, s[16:19], s54 offen lds
    s_waitcnt lgkmcnt(6)
    v_mfma_f32_32x32x16_bf16 v[80:95], v[48:51], v[208:211], v[80:95]
    ds_read_b64_tr_b16 v[32:33], v21 offset:4096
    ds_read_b64_tr_b16 v[34:35], v21 offset:4352
    s_add_u32 m0, s59, 65536
    s_nop 0
    buffer_load_dwordx4 v14, s[16:19], s55 offen lds
    s_waitcnt lgkmcnt(6)
    v_mfma_f32_32x32x16_bf16 v[80:95], v[52:55], v[212:215], v[80:95]
    ds_read_b64_tr_b16 v[36:37], v21 offset:5120
    ds_read_b64_tr_b16 v[38:39], v21 offset:5376
    s_add_u32 m0, s59, 69632
    s_nop 0
    buffer_load_dwordx4 v14, s[16:19], s56 offen lds
    s_waitcnt lgkmcnt(6)
    v_mfma_f32_32x32x16_bf16 v[80:95], v[56:59], v[216:219], v[80:95]
    ds_read_b64_tr_b16 v[40:41], v21 offset:6144
    ds_read_b64_tr_b16 v[42:43], v21 offset:6400
    s_add_u32 m0, s59, 73728
    s_nop 0
    buffer_load_dwordx4 v14, s[16:19], s57 offen lds
    s_waitcnt lgkmcnt(6)
    v_mfma_f32_32x32x16_bf16 v[80:95], v[60:63], v[220:223], v[80:95]
    ds_read_b64_tr_b16 v[44:45], v21 offset:7168
    ds_read_b64_tr_b16 v[46:47], v21 offset:7424
    s_movk_i32 s48, 4096
    s_waitcnt lgkmcnt(6)
    v_mfma_f32_32x32x16_bf16 v[80:95], v[32:35], v[224:227], v[80:95]
    s_movk_i32 s49, 8192
    s_waitcnt lgkmcnt(4)
    v_mfma_f32_32x32x16_bf16 v[80:95], v[36:39], v[228:231], v[80:95]
    s_movk_i32 s50, 12288
    s_waitcnt lgkmcnt(2)
    v_mfma_f32_32x32x16_bf16 v[80:95], v[40:43], v[232:235], v[80:95]
    s_waitcnt lgkmcnt(0)
    v_mfma_f32_32x32x16_bf16 v[80:95], v[44:47], v[236:239], v[80:95]
    v_mov_b32 v122, 0x3f80
    v_mov_b32 v123, 0
    s_nop 9
    v_cvt_pk_bf16_f32 v116, v80, v81
    v_cvt_pk_bf16_f32 v117, v82, v83
    v_cvt_pk_bf16_f32 v118, v84, v85
    v_cvt_pk_bf16_f32 v119, v86, v87
    ds_write_b128 v30, v[116:119]
    v_cvt_pk_bf16_f32 v120, v88, v89
    v_cvt_pk_bf16_f32 v121, v90, v91
    s_mov_b32 exec_hi, 0
    v_cvt_pk_bf16_f32 v122, v92, v93
    v_cvt_pk_bf16_f32 v123, v94, v95
    s_mov_b32 exec_hi, -1
    ds_write_b128 v31, v[120:123]
    s_setprio 0
    s_waitcnt lgkmcnt(0)
    s_barrier
    v_lshrrev_b32 v4, 3, v1
    v_and_b32 v5, 7, v1
    v_and_b32 v8, 2, v4
    v_xor_b32 v5, v5, v8
    v_lshlrev_b32 v5, 4, v5
    s_movk_i32 s60, 896
    v_mad_u32_u24 v112, v4, s60, v5
    v_xor_b32 v5, 64, v112
    v_add_u32 v113, 5376, v5
    v_add_u32 v114, 10752, v112
    v_add_u32 v115, 16128, v5
    s_mul_i32 s38, s8, 100352
    s_lshl_b32 s60, s10, 7
    s_add_u32 s38, s38, s60
    s_mul_i32 s39, s8, 14336
    s_add_u32 s39, s39, 81920
    s_lshr_b32 s60, s8, 1
    s_lshl_b32 s60, s60, 5
    s_add_u32 s60, s60, s9
    s_and_b32 s61, s8, 1
    s_lshl_b32 s62, s61, 10
    s_add_u32 s63, s62, s60
    v_and_b32 v4, 15, v1
    v_lshrrev_b32 v5, 4, v1
    v_lshl_add_u32 v6, v4, 6, s63
    v_cvt_f32_u32 v7, v6
    v_mul_f32 v7, 0x3a000000, v7
    v_lshl_add_u32 v8, v5, 2, 32
    v_cvt_f32_u32 v8, v8
    v_mul_f32 v8, v8, v7
    s_cmp_ge_u32 s10, 4
    s_cselect_b32 s64, 0x80000000, 0
    s_cmp_ge_u32 s10, 3
    s_cselect_b32 s65, 0x80000000, 0
    s_movk_i32 s66, 896
    v_mul_u32_u24 v15, s66, v6
    v_and_b32 v6, 1, v5
    v_lshl_add_u32 v15, v6, 5, v15
    v_lshrrev_b32 v6, 1, v5
    v_lshl_add_u32 v15, v6, 4, v15
    s_lshl_b32 s66, s10, 7
    s_add_u32 s66, s66, 64
    v_add_u32 v15, s66, v15
    s_lshl_b32 s60, s60, 1
    s_add_u32 s60, s60, s61
    s_lshl_b32 s66, s60, 7
    s_add_u32 s66, s66, 5308416
    v_lshl_add_u32 v29, v4, 3, s66
    s_lshl_b32 s60, s60, 14
    s_add_u32 s60, s60, 8192
    v_add_u32 v14, s60, v3
    v_lshlrev_b32 v23, 4, v4
    v_lshl_add_u32 v23, v5, 10, v23
    v_add_u32 v23, 40960, v23
    v_mov_b32 v9, v8
    v_cos_f32 v6, v9
    v_sin_f32 v9, v9
    s_nop 0
    v_cvt_pk_bf16_f32 v96, v6, v9
    v_xor_b32 v104, s65, v96
    v_xor_b32 v96, s64, v96
    v_fmamk_f32 v9, v7, 0x3f800000, v8
    v_cos_f32 v6, v9
    v_sin_f32 v9, v9
    s_nop 0
    v_cvt_pk_bf16_f32 v97, v6, v9
    v_xor_b32 v105, s65, v97
    v_xor_b32 v97, s64, v97
    v_fmamk_f32 v9, v7, 0x40000000, v8
    v_cos_f32 v6, v9
    v_sin_f32 v9, v9
    s_nop 0
    v_cvt_pk_bf16_f32 v98, v6, v9
    v_xor_b32 v106, s65, v98
    v_xor_b32 v98, s64, v98
    v_fmamk_f32 v9, v7, 0x40400000, v8
    v_cos_f32 v6, v9
    v_sin_f32 v9, v9
    s_nop 0
    v_cvt_pk_bf16_f32 v99, v6, v9
    v_xor_b32 v107, s65, v99
    v_xor_b32 v99, s64, v99
    v_fmamk_f32 v9, v7, 0x41800000, v8
    v_cos_f32 v6, v9
    v_sin_f32 v9, v9
    s_nop 0
    v_cvt_pk_bf16_f32 v100, v6, v9
    v_xor_b32 v108, s65, v100
    v_xor_b32 v100, s64, v100
    v_fmamk_f32 v9, v7, 0x41880000, v8
    v_cos_f32 v6, v9
    v_sin_f32 v9, v9
    s_nop 0
    v_cvt_pk_bf16_f32 v101, v6, v9
    v_xor_b32 v109, s65, v101
    v_xor_b32 v101, s64, v101
    v_fmamk_f32 v9, v7, 0x41900000, v8
    v_cos_f32 v6, v9
    v_sin_f32 v9, v9
    s_nop 0
    v_cvt_pk_bf16_f32 v102, v6, v9
    v_xor_b32 v110, s65, v102
    v_xor_b32 v102, s64, v102
    v_fmamk_f32 v9, v7, 0x41980000, v8
    v_cos_f32 v6, v9
    v_sin_f32 v9, v9
    s_nop 0
    v_cvt_pk_bf16_f32 v103, v6, v9
    v_xor_b32 v111, s65, v103
    v_xor_b32 v103, s64, v103
    v_bfe_u32 v6, v1, 2, 2
    v_mad_u32_u24 v6, v5, 7, v6
    v_bfe_u32 v7, v1, 3, 2
    v_bfe_u32 v8, v1, 1, 1
    v_lshl_or_b32 v8, v7, 1, v8
    v_lshlrev_b32 v8, 4, v8
    v_lshl_add_u32 v8, v6, 7, v8
    v_and_b32 v7, 1, v1
    v_lshl_add_u32 v8, v7, 3, v8
    v_add_u32 v24, 110592, v8
    v_xor_b32 v25, 32, v24
    v_xor_b32 v26, 64, v24
    v_xor_b32 v27, 0x60, v24
    s_lshl_b32 s60, s3, 11
    v_add_u32 v28, s60, v3
    v_xor_b32 v30, 0x2000, v28
    s_waitcnt vmcnt(0)
    s_barrier
    s_lshl_b32 s61, s4, 4
    s_add_u32 s61, s61, s5
    s_lshl_b32 s61, s61, 2
    s_add_u32 s61, s61, s8
    s_lshl_b32 s61, s61, 7
    s_add_u32 s61, s61, 5373952
    v_mov_b32 v4, s36
    v_mov_b32 v5, s61
    s_mov_b64 exec, 1
    buffer_store_dword v4, v5, s[32:35], 0 offen sc1
    s_mov_b64 exec, -1
    s_add_u32 m0, s39, 0
    s_add_u32 s61, s38, 0
    s_mov_b32 exec_hi, 0xffffff
    buffer_load_dwordx4 v112, s[24:27], s61 offen offset:0 lds
    buffer_load_dwordx4 v113, s[24:27], s61 offen offset:896 lds
    buffer_load_dwordx4 v114, s[24:27], s61 offen offset:1792 lds
    buffer_load_dwordx4 v115, s[24:27], s61 offen offset:2688 lds
    s_mov_b32 exec_hi, -1
    s_add_u32 m0, s39, 3584
    s_add_u32 s61, s38, 25088
    s_mov_b32 exec_hi, 0xffffff
    buffer_load_dwordx4 v112, s[24:27], s61 offen offset:0 lds
    buffer_load_dwordx4 v113, s[24:27], s61 offen offset:896 lds
    buffer_load_dwordx4 v114, s[24:27], s61 offen offset:1792 lds
    buffer_load_dwordx4 v115, s[24:27], s61 offen offset:2688 lds
    s_mov_b32 exec_hi, -1
    s_add_u32 m0, s39, 7168
    s_add_u32 s61, s38, 50176
    s_mov_b32 exec_hi, 0xffffff
    buffer_load_dwordx4 v112, s[24:27], s61 offen offset:0 lds
    buffer_load_dwordx4 v113, s[24:27], s61 offen offset:896 lds
    buffer_load_dwordx4 v114, s[24:27], s61 offen offset:1792 lds
    buffer_load_dwordx4 v115, s[24:27], s61 offen offset:2688 lds
    s_mov_b32 exec_hi, -1
    s_add_u32 m0, s39, 10752
    s_add_u32 s61, s38, 75264
    s_mov_b32 exec_hi, 0xffffff
    buffer_load_dwordx4 v112, s[24:27], s61 offen offset:0 lds
    buffer_load_dwordx4 v113, s[24:27], s61 offen offset:896 lds
    buffer_load_dwordx4 v114, s[24:27], s61 offen offset:1792 lds
    buffer_load_dwordx4 v115, s[24:27], s61 offen offset:2688 lds
    s_mov_b32 exec_hi, -1
    s_movk_i32 s60, 10836
    s_bitcmp1_b32 s60, s6
    s_cbranch_scc0 B_PI
    s_waitcnt vmcnt(0)
B_PI:
    buffer_load_dwordx4 v[128:131], v13, s[32:35], 0 offen sc1
    buffer_load_dwordx4 v[132:135], v13, s[32:35], 0 offen offset:1024 sc1
    buffer_load_dwordx4 v[136:139], v13, s[32:35], 0 offen offset:2048 sc1
    buffer_load_dwordx4 v[140:143], v13, s[32:35], 0 offen offset:3072 sc1
    buffer_load_dwordx4 v[144:147], v13, s[32:35], s48 offen sc1
    buffer_load_dwordx4 v[148:151], v13, s[32:35], s48 offen offset:1024 sc1
    buffer_load_dwordx4 v[152:155], v13, s[32:35], s48 offen offset:2048 sc1
    buffer_load_dwordx4 v[156:159], v13, s[32:35], s48 offen offset:3072 sc1
    buffer_load_dwordx4 v[160:163], v13, s[32:35], s49 offen sc1
    buffer_load_dwordx4 v[164:167], v13, s[32:35], s49 offen offset:1024 sc1
    buffer_load_dwordx4 v[168:171], v13, s[32:35], s49 offen offset:2048 sc1
    buffer_load_dwordx4 v[172:175], v13, s[32:35], s49 offen offset:3072 sc1
    buffer_load_dwordx4 v[176:179], v13, s[32:35], s50 offen sc1
    buffer_load_dwordx4 v[180:183], v13, s[32:35], s50 offen offset:1024 sc1
    buffer_load_dwordx4 v[184:187], v13, s[32:35], s50 offen offset:2048 sc1
    buffer_load_dwordx4 v[188:191], v13, s[32:35], s50 offen offset:3072 sc1
    s_setprio 1
    v_bfe_u32 v4, v1, 3, 2
    v_and_b32 v5, 3, v1
    v_lshl_add_u32 v4, v4, 2, v5
    v_bfe_u32 v5, v1, 2, 1
    v_lshrrev_b32 v6, 5, v1
    v_xor_b32 v5, v5, v6
    v_lshl_add_u32 v4, v5, 4, v4
    v_and_b32 v5, 1, v4
    v_lshlrev_b32 v5, 4, v5
    v_mov_b32 v6, 0x3f80
    v_lshlrev_b32 v5, v5, v6
    v_lshrrev_b32 v6, 1, v4
    v_cmp_eq_u32 vcc, 0, v6
    s_nop 1
    v_cndmask_b32 v208, 0, v5, vcc
    v_cmp_eq_u32 vcc, 1, v6
    s_nop 1
    v_cndmask_b32 v209, 0, v5, vcc
    v_cmp_eq_u32 vcc, 2, v6
    s_nop 1
    v_cndmask_b32 v210, 0, v5, vcc
    v_cmp_eq_u32 vcc, 6, v4
    s_nop 1
    v_cndmask_b32 v211, 0, v5, vcc
    s_lshl_b32 s60, s10, 6
    v_add_u32 v4, s60, v1
    v_sub_u32 v5, 448, v4
    s_movk_i32 s61, 224
    v_cmp_le_u32 vcc, s61, v4
    s_nop 1
    v_cndmask_b32 v4, v4, v5, vcc
    s_sub_u32 s61, 32, s9
    s_and_b32 s61, s61, 31
    v_mov_b32 v5, s9
    v_mov_b32 v6, s61
    v_cndmask_b32 v5, v5, v6, vcc
    v_mul_u32_u24 v6, 4682, v4
    v_lshrrev_b32 v6, 16, v6
    v_lshl_add_u32 v4, v6, 1, v4
    v_lshlrev_b32 v4, 4, v4
    v_min_u32 v4, 4080, v4
    v_lshl_add_u32 v10, v5, 16, v4
    v_min_u32 v6, 15, v6
    v_bfe_u32 v5, v5, 2, 2
    v_lshl_add_u32 v5, v6, 2, v5
    v_and_b32 v4, 15, v1
    v_bfe_u32 v6, v1, 3, 1
    v_lshlrev_b32 v4, 4, v4
    v_mad_u32_u24 v4, v6, 12, v4
    ds_bpermute_b32 v2, v4, v5
    v_lshrrev_b32 v4, 4, v1
    s_lshl_b32 s37, s8, 15
    s_add_u32 s37, s37, 5373952
    s_lshl_b32 s60, s8, 14
    s_add_u32 s60, s60, 2097152
    v_add_u32 v10, s60, v10
    s_lshl_b32 s61, s8, 12
    s_add_u32 s61, s61, 32768
    v_add_u32 v11, s61, v3
    s_lshl_b32 s60, s8, 10
    s_add_u32 s60, s60, 152064
    v_add_u32 v12, s60, v3
    s_waitcnt lgkmcnt(0)
    v_lshl_add_u32 v2, v4, 6, v2
    v_lshlrev_b32 v2, 7, v2
    buffer_load_dword v127, v2, s[32:35], s37 offen sc1
    s_movk_i32 s67, 400
PG_CK0:
    s_waitcnt vmcnt(16)
    v_cmp_ne_u32_sdwa vcc, v131, s36 src0_sel:WORD_1 src1_sel:WORD_1
    s_cbranch_vccnz PG_RT0
PG_OK0:
    v_mfma_f32_32x32x16_bf16 v[192:207], v[208:211], v[128:131], 0
PG_CK1:
    s_waitcnt vmcnt(15)
    v_cmp_ne_u32_sdwa vcc, v135, s36 src0_sel:WORD_1 src1_sel:WORD_1
    s_cbranch_vccnz PG_RT1
PG_OK1:
    v_mfma_f32_32x32x16_bf16 v[192:207], v[208:211], v[132:135], v[192:207]
PG_CK2:
    s_waitcnt vmcnt(14)
    v_cmp_ne_u32_sdwa vcc, v139, s36 src0_sel:WORD_1 src1_sel:WORD_1
    s_cbranch_vccnz PG_RT2
PG_OK2:
    v_mfma_f32_32x32x16_bf16 v[192:207], v[208:211], v[136:139], v[192:207]
PG_CK3:
    s_waitcnt vmcnt(13)
    v_cmp_ne_u32_sdwa vcc, v143, s36 src0_sel:WORD_1 src1_sel:WORD_1
    s_cbranch_vccnz PG_RT3
PG_OK3:
    v_mfma_f32_32x32x16_bf16 v[192:207], v[208:211], v[140:143], v[192:207]
PG_CK4:
    s_waitcnt vmcnt(12)
    v_cmp_ne_u32_sdwa vcc, v147, s36 src0_sel:WORD_1 src1_sel:WORD_1
    s_cbranch_vccnz PG_RT4
PG_OK4:
    v_mfma_f32_32x32x16_bf16 v[192:207], v[208:211], v[144:147], v[192:207]
PG_CK5:
    s_waitcnt vmcnt(11)
    v_cmp_ne_u32_sdwa vcc, v151, s36 src0_sel:WORD_1 src1_sel:WORD_1
    s_cbranch_vccnz PG_RT5
PG_OK5:
    v_mfma_f32_32x32x16_bf16 v[192:207], v[208:211], v[148:151], v[192:207]
PG_CK6:
    s_waitcnt vmcnt(10)
    v_cmp_ne_u32_sdwa vcc, v155, s36 src0_sel:WORD_1 src1_sel:WORD_1
    s_cbranch_vccnz PG_RT6
PG_OK6:
    v_mfma_f32_32x32x16_bf16 v[192:207], v[208:211], v[152:155], v[192:207]
PG_CK7:
    s_waitcnt vmcnt(9)
    v_cmp_ne_u32_sdwa vcc, v159, s36 src0_sel:WORD_1 src1_sel:WORD_1
    s_cbranch_vccnz PG_RT7
PG_OK7:
    v_mfma_f32_32x32x16_bf16 v[192:207], v[208:211], v[156:159], v[192:207]
PG_CK8:
    s_waitcnt vmcnt(8)
    v_cmp_ne_u32_sdwa vcc, v163, s36 src0_sel:WORD_1 src1_sel:WORD_1
    s_cbranch_vccnz PG_RT8
PG_OK8:
    v_mfma_f32_32x32x16_bf16 v[192:207], v[208:211], v[160:163], v[192:207]
PG_CK9:
    s_waitcnt vmcnt(7)
    v_cmp_ne_u32_sdwa vcc, v167, s36 src0_sel:WORD_1 src1_sel:WORD_1
    s_cbranch_vccnz PG_RT9
PG_OK9:
    v_mfma_f32_32x32x16_bf16 v[192:207], v[208:211], v[164:167], v[192:207]
PG_CK10:
    s_waitcnt vmcnt(6)
    v_cmp_ne_u32_sdwa vcc, v171, s36 src0_sel:WORD_1 src1_sel:WORD_1
    s_cbranch_vccnz PG_RT10
PG_OK10:
    v_mfma_f32_32x32x16_bf16 v[192:207], v[208:211], v[168:171], v[192:207]
PG_CK11:
    s_waitcnt vmcnt(5)
    v_cmp_ne_u32_sdwa vcc, v175, s36 src0_sel:WORD_1 src1_sel:WORD_1
    s_cbranch_vccnz PG_RT11
PG_OK11:
    v_mfma_f32_32x32x16_bf16 v[192:207], v[208:211], v[172:175], v[192:207]
PG_CK12:
    s_waitcnt vmcnt(4)
    v_cmp_ne_u32_sdwa vcc, v179, s36 src0_sel:WORD_1 src1_sel:WORD_1
    s_cbranch_vccnz PG_RT12
PG_OK12:
    v_mfma_f32_32x32x16_bf16 v[192:207], v[208:211], v[176:179], v[192:207]
PG_CK13:
    s_waitcnt vmcnt(3)
    v_cmp_ne_u32_sdwa vcc, v183, s36 src0_sel:WORD_1 src1_sel:WORD_1
    s_cbranch_vccnz PG_RT13
PG_OK13:
    v_mfma_f32_32x32x16_bf16 v[192:207], v[208:211], v[180:183], v[192:207]
PG_CK14:
    s_waitcnt vmcnt(2)
    v_cmp_ne_u32_sdwa vcc, v187, s36 src0_sel:WORD_1 src1_sel:WORD_1
    s_cbranch_vccnz PG_RT14
PG_OK14:
    v_mfma_f32_32x32x16_bf16 v[192:207], v[208:211], v[184:187], v[192:207]
PG_CK15:
    s_waitcnt vmcnt(1)
    v_cmp_ne_u32_sdwa vcc, v191, s36 src0_sel:WORD_1 src1_sel:WORD_1
    s_cbranch_vccnz PG_RT15
PG_OK15:
    v_mfma_f32_32x32x16_bf16 v[192:207], v[208:211], v[188:191], v[192:207]
    s_nop 11
    v_cvt_pk_bf16_f32 v200, v192, v193
    v_cvt_pk_bf16_f32 v201, v194, v195
    v_cvt_pk_bf16_f32 v202, v196, v197
    v_cvt_pk_bf16_f32 v203, v198, v199
    ds_write_b128 v12, v[200:203]
    s_setprio 0
    s_waitcnt lgkmcnt(0)
    s_cmp_ge_u32 s10, 7
    s_cbranch_scc1 B_J7
    s_waitcnt vmcnt(17)
    s_waitcnt vmcnt(0)
    v_cmp_ne_u32 vcc, s36, v127
    s_cbranch_vccnz B_ULATE
    buffer_load_dwordx4 v[112:115], v10, s[32:35], 0 offen sc1
    buffer_load_dwordx4 v[116:119], v10, s[32:35], s48 offen sc1
    buffer_load_dwordx4 v[120:123], v10, s[32:35], s49 offen sc1
    buffer_load_dwordx4 v[124:127], v10, s[32:35], s50 offen sc1
    s_barrier
B_BS:
    buffer_load_dwordx2 v[20:21], v29, s[32:35], 0 offen sc1
    ds_read_b64_tr_b16 v[128:129], v24 offset:0
    ds_read_b64_tr_b16 v[130:131], v24 offset:512
    ds_read_b64_tr_b16 v[132:133], v25 offset:0
    ds_read_b64_tr_b16 v[134:135], v25 offset:512
    ds_read_b64_tr_b16 v[136:137], v26 offset:0
    ds_read_b64_tr_b16 v[138:139], v26 offset:512
    ds_read_b64_tr_b16 v[140:141], v27 offset:0
    ds_read_b64_tr_b16 v[142:143], v27 offset:512
    ds_read_b64_tr_b16 v[144:145], v24 offset:3584
    ds_read_b64_tr_b16 v[146:147], v24 offset:4096
    ds_read_b64_tr_b16 v[148:149], v25 offset:3584
    ds_read_b64_tr_b16 v[150:151], v25 offset:4096
    ds_read_b64_tr_b16 v[152:153], v26 offset:3584
    ds_read_b64_tr_b16 v[154:155], v26 offset:4096
    ds_read_b64_tr_b16 v[156:157], v27 offset:3584
    ds_read_b64_tr_b16 v[158:159], v27 offset:4096
    ds_read_b64_tr_b16 v[160:161], v24 offset:7168
    ds_read_b64_tr_b16 v[162:163], v24 offset:7680
    ds_read_b64_tr_b16 v[164:165], v25 offset:7168
    ds_read_b64_tr_b16 v[166:167], v25 offset:7680
    ds_read_b64_tr_b16 v[168:169], v26 offset:7168
    ds_read_b64_tr_b16 v[170:171], v26 offset:7680
    ds_read_b64_tr_b16 v[172:173], v27 offset:7168
    ds_read_b64_tr_b16 v[174:175], v27 offset:7680
    ds_read_b64_tr_b16 v[176:177], v24 offset:10752
    ds_read_b64_tr_b16 v[178:179], v24 offset:11264
    ds_read_b64_tr_b16 v[180:181], v25 offset:10752
    ds_read_b64_tr_b16 v[182:183], v25 offset:11264
    ds_read_b64_tr_b16 v[184:185], v26 offset:10752
    ds_read_b64_tr_b16 v[186:187], v26 offset:11264
    ds_read_b64_tr_b16 v[188:189], v27 offset:10752
    ds_read_b64_tr_b16 v[190:191], v27 offset:11264
    ds_read_b64_tr_b16 v[192:193], v24 offset:14336
    ds_read_b64_tr_b16 v[194:195], v24 offset:14848
    ds_read_b64_tr_b16 v[196:197], v25 offset:14336
    ds_read_b64_tr_b16 v[198:199], v25 offset:14848
    ds_read_b64_tr_b16 v[200:201], v26 offset:14336
    ds_read_b64_tr_b16 v[202:203], v26 offset:14848
    ds_read_b64_tr_b16 v[204:205], v27 offset:14336
    ds_read_b64_tr_b16 v[206:207], v27 offset:14848
    ds_read_b64_tr_b16 v[208:209], v24 offset:17920
    ds_read_b64_tr_b16 v[210:211], v24 offset:18432
    ds_read_b64_tr_b16 v[212:213], v25 offset:17920
    ds_read_b64_tr_b16 v[214:215], v25 offset:18432
    ds_read_b64_tr_b16 v[216:217], v26 offset:17920
    ds_read_b64_tr_b16 v[218:219], v26 offset:18432
    ds_read_b64_tr_b16 v[220:221], v27 offset:17920
    ds_read_b64_tr_b16 v[222:223], v27 offset:18432
    ds_read_b64_tr_b16 v[224:225], v24 offset:21504
    ds_read_b64_tr_b16 v[226:227], v24 offset:22016
    ds_read_b64_tr_b16 v[228:229], v25 offset:21504
    ds_read_b64_tr_b16 v[230:231], v25 offset:22016
    ds_read_b64_tr_b16 v[232:233], v26 offset:21504
    ds_read_b64_tr_b16 v[234:235], v26 offset:22016
    ds_read_b64_tr_b16 v[236:237], v27 offset:21504
    ds_read_b64_tr_b16 v[238:239], v27 offset:22016
    ds_read_b64_tr_b16 v[240:241], v24 offset:25088
    ds_read_b64_tr_b16 v[242:243], v24 offset:25600
    ds_read_b64_tr_b16 v[244:245], v25 offset:25088
    ds_read_b64_tr_b16 v[246:247], v25 offset:25600
    ds_read_b64_tr_b16 v[248:249], v26 offset:25088
    ds_read_b64_tr_b16 v[250:251], v26 offset:25600
    ds_read_b64_tr_b16 v[252:253], v27 offset:25088
    ds_read_b64_tr_b16 v[254:255], v27 offset:25600
    s_waitcnt vmcnt(4)
    ds_write_b128 v11, v[112:115] offset:0
    s_waitcnt vmcnt(3)
    ds_write_b128 v11, v[116:119] offset:1024
    s_waitcnt vmcnt(2)
    ds_write_b128 v11, v[120:123] offset:2048
    s_waitcnt vmcnt(1)
    ds_write_b128 v11, v[124:127] offset:3072
    s_waitcnt lgkmcnt(0)
    s_barrier
    ds_read_b128 v[64:67], v23 offset:0
    ds_read_b128 v[68:71], v23 offset:256
    ds_read_b128 v[72:75], v23 offset:512
    ds_read_b128 v[76:79], v23 offset:768
    ds_read_b128 v[80:83], v23 offset:4096
    ds_read_b128 v[84:87], v23 offset:4352
    ds_read_b128 v[88:91], v23 offset:4608
    ds_read_b128 v[92:95], v23 offset:4864
    s_waitcnt lgkmcnt(7)
    v_mfma_f32_16x16x32_bf16 v[112:115], v[64:67], v[96:99], 0
    s_waitcnt lgkmcnt(6)
    v_mfma_f32_16x16x32_bf16 v[116:119], v[68:71], v[96:99], 0
    s_waitcnt lgkmcnt(5)
    v_mfma_f32_16x16x32_bf16 v[120:123], v[72:75], v[104:107], 0
    s_waitcnt lgkmcnt(4)
    v_mfma_f32_16x16x32_bf16 v[124:127], v[76:79], v[104:107], 0
    s_waitcnt lgkmcnt(3)
    v_mfma_f32_16x16x32_bf16 v[112:115], v[80:83], v[100:103], v[112:115]
    s_waitcnt lgkmcnt(2)
    v_mfma_f32_16x16x32_bf16 v[116:119], v[84:87], v[100:103], v[116:119]
    s_waitcnt lgkmcnt(1)
    v_mfma_f32_16x16x32_bf16 v[120:123], v[88:91], v[108:111], v[120:123]
    s_waitcnt lgkmcnt(0)
    v_mfma_f32_16x16x32_bf16 v[124:127], v[92:95], v[108:111], v[124:127]
    s_movk_i32 s60, 4096
    buffer_load_dwordx4 v[32:35], v14, s[32:35], 0 offen sc1
    buffer_load_dwordx4 v[36:39], v14, s[32:35], 0 offen offset:1024 sc1
    buffer_load_dwordx4 v[40:43], v14, s[32:35], 0 offen offset:2048 sc1
    buffer_load_dwordx4 v[44:47], v14, s[32:35], 0 offen offset:3072 sc1
    buffer_load_dwordx4 v[48:51], v14, s[32:35], s60 offen sc1
    buffer_load_dwordx4 v[52:55], v14, s[32:35], s60 offen offset:1024 sc1
    buffer_load_dwordx4 v[56:59], v14, s[32:35], s60 offen offset:2048 sc1
    buffer_load_dwordx4 v[60:63], v14, s[32:35], s60 offen offset:3072 sc1
    s_movk_i32 s67, 400
GB_CK0:
    s_waitcnt vmcnt(8)
    v_cmp_ne_u32 vcc, s36, v21
    s_cbranch_vccnz GB_RT0
GB_OK0:
    v_mul_f32 v112, v112, v20
    v_mul_f32 v113, v113, v20
    v_mul_f32 v114, v114, v20
    v_mul_f32 v115, v115, v20
    v_mul_f32 v116, v116, v20
    v_mul_f32 v117, v117, v20
    v_mul_f32 v118, v118, v20
    v_mul_f32 v119, v119, v20
    v_mul_f32 v120, v120, v20
    v_mul_f32 v121, v121, v20
    v_mul_f32 v122, v122, v20
    v_mul_f32 v123, v123, v20
    v_mul_f32 v124, v124, v20
    v_mul_f32 v125, v125, v20
    v_mul_f32 v126, v126, v20
    v_mul_f32 v127, v127, v20
    s_movk_i32 s67, 400
OB_CK0:
    s_waitcnt vmcnt(7)
    v_cmp_ne_u32_sdwa vcc, v35, s36 src0_sel:WORD_1 src1_sel:WORD_1
    v_and_b32 v35, 0xffff, v35
    s_cbranch_vccnz OB_RT0
OB_OK0:
    s_nop 0
    v_mfma_f32_16x16x32_bf16 v[112:115], v[128:131], v[32:35], v[112:115]
    v_mfma_f32_16x16x32_bf16 v[116:119], v[132:135], v[32:35], v[116:119]
    v_mfma_f32_16x16x32_bf16 v[120:123], v[136:139], v[32:35], v[120:123]
    v_mfma_f32_16x16x32_bf16 v[124:127], v[140:143], v[32:35], v[124:127]
OB_CK1:
    s_waitcnt vmcnt(6)
    v_cmp_ne_u32_sdwa vcc, v39, s36 src0_sel:WORD_1 src1_sel:WORD_1
    v_and_b32 v39, 0xffff, v39
    s_cbranch_vccnz OB_RT1
OB_OK1:
    s_nop 0
    v_mfma_f32_16x16x32_bf16 v[112:115], v[144:147], v[36:39], v[112:115]
    v_mfma_f32_16x16x32_bf16 v[116:119], v[148:151], v[36:39], v[116:119]
    v_mfma_f32_16x16x32_bf16 v[120:123], v[152:155], v[36:39], v[120:123]
    v_mfma_f32_16x16x32_bf16 v[124:127], v[156:159], v[36:39], v[124:127]
OB_CK2:
    s_waitcnt vmcnt(5)
    v_cmp_ne_u32_sdwa vcc, v43, s36 src0_sel:WORD_1 src1_sel:WORD_1
    v_and_b32 v43, 0xffff, v43
    s_cbranch_vccnz OB_RT2
OB_OK2:
    s_nop 0
    v_mfma_f32_16x16x32_bf16 v[112:115], v[160:163], v[40:43], v[112:115]
    v_mfma_f32_16x16x32_bf16 v[116:119], v[164:167], v[40:43], v[116:119]
    v_mfma_f32_16x16x32_bf16 v[120:123], v[168:171], v[40:43], v[120:123]
    v_mfma_f32_16x16x32_bf16 v[124:127], v[172:175], v[40:43], v[124:127]
OB_CK3:
    s_waitcnt vmcnt(4)
    v_cmp_ne_u32_sdwa vcc, v47, s36 src0_sel:WORD_1 src1_sel:WORD_1
    v_and_b32 v47, 0xffff, v47
    s_cbranch_vccnz OB_RT3
OB_OK3:
    s_nop 0
    v_mfma_f32_16x16x32_bf16 v[112:115], v[176:179], v[44:47], v[112:115]
    v_mfma_f32_16x16x32_bf16 v[116:119], v[180:183], v[44:47], v[116:119]
    v_mfma_f32_16x16x32_bf16 v[120:123], v[184:187], v[44:47], v[120:123]
    v_mfma_f32_16x16x32_bf16 v[124:127], v[188:191], v[44:47], v[124:127]
OB_CK4:
    s_waitcnt vmcnt(3)
    v_cmp_ne_u32_sdwa vcc, v51, s36 src0_sel:WORD_1 src1_sel:WORD_1
    v_and_b32 v51, 0xffff, v51
    s_cbranch_vccnz OB_RT4
OB_OK4:
    s_nop 0
    v_mfma_f32_16x16x32_bf16 v[112:115], v[192:195], v[48:51], v[112:115]
    v_mfma_f32_16x16x32_bf16 v[116:119], v[196:199], v[48:51], v[116:119]
    v_mfma_f32_16x16x32_bf16 v[120:123], v[200:203], v[48:51], v[120:123]
    v_mfma_f32_16x16x32_bf16 v[124:127], v[204:207], v[48:51], v[124:127]
OB_CK5:
    s_waitcnt vmcnt(2)
    v_cmp_ne_u32_sdwa vcc, v55, s36 src0_sel:WORD_1 src1_sel:WORD_1
    v_and_b32 v55, 0xffff, v55
    s_cbranch_vccnz OB_RT5
OB_OK5:
    s_nop 0
    v_mfma_f32_16x16x32_bf16 v[112:115], v[208:211], v[52:55], v[112:115]
    v_mfma_f32_16x16x32_bf16 v[116:119], v[212:215], v[52:55], v[116:119]
    v_mfma_f32_16x16x32_bf16 v[120:123], v[216:219], v[52:55], v[120:123]
    v_mfma_f32_16x16x32_bf16 v[124:127], v[220:223], v[52:55], v[124:127]
OB_CK6:
    s_waitcnt vmcnt(1)
    v_cmp_ne_u32_sdwa vcc, v59, s36 src0_sel:WORD_1 src1_sel:WORD_1
    v_and_b32 v59, 0xffff, v59
    s_cbranch_vccnz OB_RT6
OB_OK6:
    s_nop 0
    v_mfma_f32_16x16x32_bf16 v[112:115], v[224:227], v[56:59], v[112:115]
    v_mfma_f32_16x16x32_bf16 v[116:119], v[228:231], v[56:59], v[116:119]
    v_mfma_f32_16x16x32_bf16 v[120:123], v[232:235], v[56:59], v[120:123]
    v_mfma_f32_16x16x32_bf16 v[124:127], v[236:239], v[56:59], v[124:127]
OB_CK7:
    s_waitcnt vmcnt(0)
    v_cmp_ne_u32_sdwa vcc, v63, s36 src0_sel:WORD_1 src1_sel:WORD_1
    v_and_b32 v63, 0xffff, v63
    s_cbranch_vccnz OB_RT7
OB_OK7:
    s_nop 0
    v_mfma_f32_16x16x32_bf16 v[112:115], v[240:243], v[60:63], v[112:115]
    v_mfma_f32_16x16x32_bf16 v[116:119], v[244:247], v[60:63], v[116:119]
    v_mfma_f32_16x16x32_bf16 v[120:123], v[248:251], v[60:63], v[120:123]
    v_mfma_f32_16x16x32_bf16 v[124:127], v[252:255], v[60:63], v[124:127]
    s_nop 4
    ds_write_b128 v28, v[112:115] offset:0
    ds_write_b128 v28, v[116:119] offset:1024
    s_waitcnt lgkmcnt(0)
    s_barrier
    ds_read_b128 v[64:67], v30 offset:0
    ds_read_b128 v[68:71], v30 offset:1024
    s_waitcnt lgkmcnt(1)
    v_add_f32 v120, v120, v64
    v_add_f32 v121, v121, v65
    v_add_f32 v122, v122, v66
    v_add_f32 v123, v123, v67
    v_cvt_pk_bf16_f32 v32, v120, v121
    v_cvt_pk_bf16_f32 v33, v122, v123
    s_waitcnt lgkmcnt(0)
    v_add_f32 v124, v124, v68
    v_add_f32 v125, v125, v69
    v_add_f32 v126, v126, v70
    v_add_f32 v127, v127, v71
    v_cvt_pk_bf16_f32 v34, v124, v125
    v_cvt_pk_bf16_f32 v35, v126, v127
    s_nop 0
    v_permlane16_swap_b32 v32, v34
    v_permlane16_swap_b32 v33, v35
    buffer_store_dwordx4 v[32:35], v15, s[40:43], 0 offen sc1
    s_lshl_b32 s60, s2, 3
    s_add_u32 s60, s60, s3
    s_cmp_lg_u32 s60, 4
    s_cbranch_scc1 B_FIN
    v_mov_b32 v4, s36
    v_mov_b32 v5, 5246976
    s_mov_b64 exec, 1
    buffer_store_dword v4, v5, s[32:35], 0 offen sc1
B_FIN:
K_END:
    s_endpgm
B_USPIN:
    s_movk_i32 s67, 2000
B_USP:
    buffer_load_dword v127, v2, s[32:35], s37 offen sc1
    s_sub_u32 s67, s67, 1
    s_waitcnt vmcnt(0)
    s_cmp_eq_u32 s67, 0
    s_cbranch_scc1 B_UOK
    v_cmp_ne_u32 vcc, s36, v127
    s_cbranch_vccnz B_USP
    s_branch B_UOK
PG_RT0:
    s_movk_i32 s68, 0
    s_sub_u32 s67, s67, 1
    s_cmp_eq_u32 s67, 0
    s_cbranch_scc1 PG_GU0
    s_waitcnt vmcnt(0)
    s_branch PG_CH0
PG_GU0:
    s_movk_i32 s67, 1
    s_waitcnt vmcnt(0)
    s_branch PG_OK0
PG_RT1:
    s_movk_i32 s68, 1
    s_sub_u32 s67, s67, 1
    s_cmp_eq_u32 s67, 0
    s_cbranch_scc1 PG_GU1
    s_waitcnt vmcnt(0)
    s_branch PG_CH1
PG_GU1:
    s_movk_i32 s67, 1
    s_waitcnt vmcnt(0)
    s_branch PG_OK1
PG_RT2:
    s_movk_i32 s68, 2
    s_sub_u32 s67, s67, 1
    s_cmp_eq_u32 s67, 0
    s_cbranch_scc1 PG_GU2
    s_waitcnt vmcnt(0)
    s_branch PG_CH2
PG_GU2:
    s_movk_i32 s67, 1
    s_waitcnt vmcnt(0)
    s_branch PG_OK2
PG_RT3:
    s_movk_i32 s68, 3
    s_sub_u32 s67, s67, 1
    s_cmp_eq_u32 s67, 0
    s_cbranch_scc1 PG_GU3
    s_waitcnt vmcnt(0)
    s_branch PG_CH3
PG_GU3:
    s_movk_i32 s67, 1
    s_waitcnt vmcnt(0)
    s_branch PG_OK3
PG_RT4:
    s_movk_i32 s68, 4
    s_sub_u32 s67, s67, 1
    s_cmp_eq_u32 s67, 0
    s_cbranch_scc1 PG_GU4
    s_waitcnt vmcnt(0)
    s_branch PG_CH4
PG_GU4:
    s_movk_i32 s67, 1
    s_waitcnt vmcnt(0)
    s_branch PG_OK4
PG_RT5:
    s_movk_i32 s68, 5
    s_sub_u32 s67, s67, 1
    s_cmp_eq_u32 s67, 0
    s_cbranch_scc1 PG_GU5
    s_waitcnt vmcnt(0)
    s_branch PG_CH5
PG_GU5:
    s_movk_i32 s67, 1
    s_waitcnt vmcnt(0)
    s_branch PG_OK5
PG_RT6:
    s_movk_i32 s68, 6
    s_sub_u32 s67, s67, 1
    s_cmp_eq_u32 s67, 0
    s_cbranch_scc1 PG_GU6
    s_waitcnt vmcnt(0)
    s_branch PG_CH6
PG_GU6:
    s_movk_i32 s67, 1
    s_waitcnt vmcnt(0)
    s_branch PG_OK6
PG_RT7:
    s_movk_i32 s68, 7
    s_sub_u32 s67, s67, 1
    s_cmp_eq_u32 s67, 0
    s_cbranch_scc1 PG_GU7
    s_waitcnt vmcnt(0)
    s_branch PG_CH7
PG_GU7:
    s_movk_i32 s67, 1
    s_waitcnt vmcnt(0)
    s_branch PG_OK7
PG_RT8:
    s_movk_i32 s68, 8
    s_sub_u32 s67, s67, 1
    s_cmp_eq_u32 s67, 0
    s_cbranch_scc1 PG_GU8
    s_waitcnt vmcnt(0)
    s_branch PG_CH8
PG_GU8:
    s_movk_i32 s67, 1
    s_waitcnt vmcnt(0)
    s_branch PG_OK8
PG_RT9:
    s_movk_i32 s68, 9
    s_sub_u32 s67, s67, 1
    s_cmp_eq_u32 s67, 0
    s_cbranch_scc1 PG_GU9
    s_waitcnt vmcnt(0)
    s_branch PG_CH9
PG_GU9:
    s_movk_i32 s67, 1
    s_waitcnt vmcnt(0)
    s_branch PG_OK9
PG_RT10:
    s_movk_i32 s68, 10
    s_sub_u32 s67, s67, 1
    s_cmp_eq_u32 s67, 0
    s_cbranch_scc1 PG_GU10
    s_waitcnt vmcnt(0)
    s_branch PG_CH10
PG_GU10:
    s_movk_i32 s67, 1
    s_waitcnt vmcnt(0)
    s_branch PG_OK10
PG_RT11:
    s_movk_i32 s68, 11
    s_sub_u32 s67, s67, 1
    s_cmp_eq_u32 s67, 0
    s_cbranch_scc1 PG_GU11
    s_waitcnt vmcnt(0)
    s_branch PG_CH11
PG_GU11:
    s_movk_i32 s67, 1
    s_waitcnt vmcnt(0)
    s_branch PG_OK11
PG_RT12:
    s_movk_i32 s68, 12
    s_sub_u32 s67, s67, 1
    s_cmp_eq_u32 s67, 0
    s_cbranch_scc1 PG_GU12
    s_waitcnt vmcnt(0)
    s_branch PG_CH12
PG_GU12:
    s_movk_i32 s67, 1
    s_waitcnt vmcnt(0)
    s_branch PG_OK12
PG_RT13:
    s_movk_i32 s68, 13
    s_sub_u32 s67, s67, 1
    s_cmp_eq_u32 s67, 0
    s_cbranch_scc1 PG_GU13
    s_waitcnt vmcnt(0)
    s_branch PG_CH13
PG_GU13:
    s_movk_i32 s67, 1
    s_waitcnt vmcnt(0)
    s_branch PG_OK13
PG_RT14:
    s_movk_i32 s68, 14
    s_sub_u32 s67, s67, 1
    s_cmp_eq_u32 s67, 0
    s_cbranch_scc1 PG_GU14
    s_waitcnt vmcnt(0)
    s_branch PG_CH14
PG_GU14:
    s_movk_i32 s67, 1
    s_waitcnt vmcnt(0)
    s_branch PG_OK14
PG_RT15:
    s_movk_i32 s68, 15
    s_sub_u32 s67, s67, 1
    s_cmp_eq_u32 s67, 0
    s_cbranch_scc1 PG_GU15
    s_waitcnt vmcnt(0)
    s_branch PG_CH15
PG_GU15:
    s_movk_i32 s67, 1
    s_waitcnt vmcnt(0)
    s_branch PG_OK15
PG_CH0:
v_cmp_ne_u32_sdwa vcc, v131, s36 src0_sel:WORD_1 src1_sel:WORD_1
s_nop 1
s_cbranch_vccz PG_CH1
buffer_load_dwordx4 v[128:131], v13, s[32:35], 0 offen sc1
PG_CH1:
v_cmp_ne_u32_sdwa vcc, v135, s36 src0_sel:WORD_1 src1_sel:WORD_1
s_nop 1
s_cbranch_vccz PG_CH2
buffer_load_dwordx4 v[132:135], v13, s[32:35], 0 offen offset:1024 sc1
PG_CH2:
v_cmp_ne_u32_sdwa vcc, v139, s36 src0_sel:WORD_1 src1_sel:WORD_1
s_nop 1
s_cbranch_vccz PG_CH3
buffer_load_dwordx4 v[136:139], v13, s[32:35], 0 offen offset:2048 sc1
PG_CH3:
v_cmp_ne_u32_sdwa vcc, v143, s36 src0_sel:WORD_1 src1_sel:WORD_1
s_nop 1
s_cbranch_vccz PG_CH4
buffer_load_dwordx4 v[140:143], v13, s[32:35], 0 offen offset:3072 sc1
PG_CH4:
v_cmp_ne_u32_sdwa vcc, v147, s36 src0_sel:WORD_1 src1_sel:WORD_1
s_nop 1
s_cbranch_vccz PG_CH5
buffer_load_dwordx4 v[144:147], v13, s[32:35], s48 offen sc1
PG_CH5:
v_cmp_ne_u32_sdwa vcc, v151, s36 src0_sel:WORD_1 src1_sel:WORD_1
s_nop 1
s_cbranch_vccz PG_CH6
buffer_load_dwordx4 v[148:151], v13, s[32:35], s48 offen offset:1024 sc1
PG_CH6:
v_cmp_ne_u32_sdwa vcc, v155, s36 src0_sel:WORD_1 src1_sel:WORD_1
s_nop 1
s_cbranch_vccz PG_CH7
buffer_load_dwordx4 v[152:155], v13, s[32:35], s48 offen offset:2048 sc1
PG_CH7:
v_cmp_ne_u32_sdwa vcc, v159, s36 src0_sel:WORD_1 src1_sel:WORD_1
s_nop 1
s_cbranch_vccz PG_CH8
buffer_load_dwordx4 v[156:159], v13, s[32:35], s48 offen offset:3072 sc1
PG_CH8:
v_cmp_ne_u32_sdwa vcc, v163, s36 src0_sel:WORD_1 src1_sel:WORD_1
s_nop 1
s_cbranch_vccz PG_CH9
buffer_load_dwordx4 v[160:163], v13, s[32:35], s49 offen sc1
PG_CH9:
v_cmp_ne_u32_sdwa vcc, v167, s36 src0_sel:WORD_1 src1_sel:WORD_1
s_nop 1
s_cbranch_vccz PG_CH10
buffer_load_dwordx4 v[164:167], v13, s[32:35], s49 offen offset:1024 sc1
PG_CH10:
v_cmp_ne_u32_sdwa vcc, v171, s36 src0_sel:WORD_1 src1_sel:WORD_1
s_nop 1
s_cbranch_vccz PG_CH11
buffer_load_dwordx4 v[168:171], v13, s[32:35], s49 offen offset:2048 sc1
PG_CH11:
v_cmp_ne_u32_sdwa vcc, v175, s36 src0_sel:WORD_1 src1_sel:WORD_1
s_nop 1
s_cbranch_vccz PG_CH12
buffer_load_dwordx4 v[172:175], v13, s[32:35], s49 offen offset:3072 sc1
PG_CH12:
v_cmp_ne_u32_sdwa vcc, v179, s36 src0_sel:WORD_1 src1_sel:WORD_1
s_nop 1
s_cbranch_vccz PG_CH13
buffer_load_dwordx4 v[176:179], v13, s[32:35], s50 offen sc1
PG_CH13:
v_cmp_ne_u32_sdwa vcc, v183, s36 src0_sel:WORD_1 src1_sel:WORD_1
s_nop 1
s_cbranch_vccz PG_CH14
buffer_load_dwordx4 v[180:183], v13, s[32:35], s50 offen offset:1024 sc1
PG_CH14:
v_cmp_ne_u32_sdwa vcc, v187, s36 src0_sel:WORD_1 src1_sel:WORD_1
s_nop 1
s_cbranch_vccz PG_CH15
buffer_load_dwordx4 v[184:187], v13, s[32:35], s50 offen offset:2048 sc1
PG_CH15:
v_cmp_ne_u32_sdwa vcc, v191, s36 src0_sel:WORD_1 src1_sel:WORD_1
s_nop 1
s_cbranch_vccz PG_CH16
buffer_load_dwordx4 v[188:191], v13, s[32:35], s50 offen offset:3072 sc1
PG_CH16:
    buffer_load_dword v127, v2, s[32:35], s37 offen sc1
    s_waitcnt vmcnt(0)
    s_cmp_eq_u32 s68, 0
    s_cbranch_scc1 PG_CK0
    s_cmp_eq_u32 s68, 1
    s_cbranch_scc1 PG_CK1
    s_cmp_eq_u32 s68, 2
    s_cbranch_scc1 PG_CK2
    s_cmp_eq_u32 s68, 3
    s_cbranch_scc1 PG_CK3
    s_cmp_eq_u32 s68, 4
    s_cbranch_scc1 PG_CK4
    s_cmp_eq_u32 s68, 5
    s_cbranch_scc1 PG_CK5
    s_cmp_eq_u32 s68, 6
    s_cbranch_scc1 PG_CK6
    s_cmp_eq_u32 s68, 7
    s_cbranch_scc1 PG_CK7
    s_cmp_eq_u32 s68, 8
    s_cbranch_scc1 PG_CK8
    s_cmp_eq_u32 s68, 9
    s_cbranch_scc1 PG_CK9
    s_cmp_eq_u32 s68, 10
    s_cbranch_scc1 PG_CK10
    s_cmp_eq_u32 s68, 11
    s_cbranch_scc1 PG_CK11
    s_cmp_eq_u32 s68, 12
    s_cbranch_scc1 PG_CK12
    s_cmp_eq_u32 s68, 13
    s_cbranch_scc1 PG_CK13
    s_cmp_eq_u32 s68, 14
    s_cbranch_scc1 PG_CK14
    s_branch PG_CK15
B_J7:
    s_waitcnt vmcnt(0)
    s_barrier
    s_branch B_FIN
B_ULATE:
    s_barrier
    s_branch B_USPIN
B_UOK:
    buffer_load_dwordx4 v[112:115], v10, s[32:35], 0 offen sc1
    buffer_load_dwordx4 v[116:119], v10, s[32:35], s48 offen sc1
    buffer_load_dwordx4 v[120:123], v10, s[32:35], s49 offen sc1
    buffer_load_dwordx4 v[124:127], v10, s[32:35], s50 offen sc1
    s_branch B_BS
GB_RT0:
    s_movk_i32 s68, 0
    s_sub_u32 s67, s67, 1
    s_cmp_eq_u32 s67, 0
    s_cbranch_scc1 GB_GU0
    s_waitcnt vmcnt(0)
    s_branch GB_CH0
GB_GU0:
    s_movk_i32 s67, 1
    s_waitcnt vmcnt(0)
    s_branch GB_OK0
GB_CH0:
v_cmp_ne_u32 vcc, s36, v21
s_nop 1
s_cbranch_vccz GB_CH1
buffer_load_dwordx2 v[20:21], v29, s[32:35], 0 offen sc1
GB_CH1:
    s_waitcnt vmcnt(0)
    s_branch GB_CK0
OB_RT0:
    s_movk_i32 s68, 0
    s_sub_u32 s67, s67, 1
    s_cmp_eq_u32 s67, 0
    s_cbranch_scc1 OB_GU0
    s_waitcnt vmcnt(0)
    s_branch OB_CH0
OB_GU0:
    s_movk_i32 s67, 1
    s_waitcnt vmcnt(0)
    s_branch OB_OK0
OB_RT1:
    s_movk_i32 s68, 1
    s_sub_u32 s67, s67, 1
    s_cmp_eq_u32 s67, 0
    s_cbranch_scc1 OB_GU1
    s_waitcnt vmcnt(0)
    s_branch OB_CH1
OB_GU1:
    s_movk_i32 s67, 1
    s_waitcnt vmcnt(0)
    s_branch OB_OK1
OB_RT2:
    s_movk_i32 s68, 2
    s_sub_u32 s67, s67, 1
    s_cmp_eq_u32 s67, 0
    s_cbranch_scc1 OB_GU2
    s_waitcnt vmcnt(0)
    s_branch OB_CH2
OB_GU2:
    s_movk_i32 s67, 1
    s_waitcnt vmcnt(0)
    s_branch OB_OK2
OB_RT3:
    s_movk_i32 s68, 3
    s_sub_u32 s67, s67, 1
    s_cmp_eq_u32 s67, 0
    s_cbranch_scc1 OB_GU3
    s_waitcnt vmcnt(0)
    s_branch OB_CH3
OB_GU3:
    s_movk_i32 s67, 1
    s_waitcnt vmcnt(0)
    s_branch OB_OK3
OB_RT4:
    s_movk_i32 s68, 4
    s_sub_u32 s67, s67, 1
    s_cmp_eq_u32 s67, 0
    s_cbranch_scc1 OB_GU4
    s_waitcnt vmcnt(0)
    s_branch OB_CH4
OB_GU4:
    s_movk_i32 s67, 1
    s_waitcnt vmcnt(0)
    s_branch OB_OK4
OB_RT5:
    s_movk_i32 s68, 5
    s_sub_u32 s67, s67, 1
    s_cmp_eq_u32 s67, 0
    s_cbranch_scc1 OB_GU5
    s_waitcnt vmcnt(0)
    s_branch OB_CH5
OB_GU5:
    s_movk_i32 s67, 1
    s_waitcnt vmcnt(0)
    s_branch OB_OK5
OB_RT6:
    s_movk_i32 s68, 6
    s_sub_u32 s67, s67, 1
    s_cmp_eq_u32 s67, 0
    s_cbranch_scc1 OB_GU6
    s_waitcnt vmcnt(0)
    s_branch OB_CH6
OB_GU6:
    s_movk_i32 s67, 1
    s_waitcnt vmcnt(0)
    s_branch OB_OK6
OB_RT7:
    s_movk_i32 s68, 7
    s_sub_u32 s67, s67, 1
    s_cmp_eq_u32 s67, 0
    s_cbranch_scc1 OB_GU7
    s_waitcnt vmcnt(0)
    s_branch OB_CH7
OB_GU7:
    s_movk_i32 s67, 1
    s_waitcnt vmcnt(0)
    s_branch OB_OK7
OB_CH0:
v_cmp_ne_u32_sdwa vcc, v35, s36 src0_sel:WORD_1 src1_sel:WORD_1
s_nop 1
s_cbranch_vccz OB_CH1
buffer_load_dwordx4 v[32:35], v14, s[32:35], 0 offen sc1
OB_CH1:
v_cmp_ne_u32_sdwa vcc, v39, s36 src0_sel:WORD_1 src1_sel:WORD_1
s_nop 1
s_cbranch_vccz OB_CH2
buffer_load_dwordx4 v[36:39], v14, s[32:35], 0 offen offset:1024 sc1
OB_CH2:
v_cmp_ne_u32_sdwa vcc, v43, s36 src0_sel:WORD_1 src1_sel:WORD_1
s_nop 1
s_cbranch_vccz OB_CH3
buffer_load_dwordx4 v[40:43], v14, s[32:35], 0 offen offset:2048 sc1
OB_CH3:
v_cmp_ne_u32_sdwa vcc, v47, s36 src0_sel:WORD_1 src1_sel:WORD_1
s_nop 1
s_cbranch_vccz OB_CH4
buffer_load_dwordx4 v[44:47], v14, s[32:35], 0 offen offset:3072 sc1
OB_CH4:
v_cmp_ne_u32_sdwa vcc, v51, s36 src0_sel:WORD_1 src1_sel:WORD_1
s_nop 1
s_cbranch_vccz OB_CH5
buffer_load_dwordx4 v[48:51], v14, s[32:35], s60 offen sc1
OB_CH5:
v_cmp_ne_u32_sdwa vcc, v55, s36 src0_sel:WORD_1 src1_sel:WORD_1
s_nop 1
s_cbranch_vccz OB_CH6
buffer_load_dwordx4 v[52:55], v14, s[32:35], s60 offen offset:1024 sc1
OB_CH6:
v_cmp_ne_u32_sdwa vcc, v59, s36 src0_sel:WORD_1 src1_sel:WORD_1
s_nop 1
s_cbranch_vccz OB_CH7
buffer_load_dwordx4 v[56:59], v14, s[32:35], s60 offen offset:2048 sc1
OB_CH7:
v_cmp_ne_u32_sdwa vcc, v63, s36 src0_sel:WORD_1 src1_sel:WORD_1
s_nop 1
s_cbranch_vccz OB_CH8
buffer_load_dwordx4 v[60:63], v14, s[32:35], s60 offen offset:3072 sc1
OB_CH8:
    s_waitcnt vmcnt(0)
    s_cmp_eq_u32 s68, 0
    s_cbranch_scc1 OB_CK0
    s_cmp_eq_u32 s68, 1
    s_cbranch_scc1 OB_CK1
    s_cmp_eq_u32 s68, 2
    s_cbranch_scc1 OB_CK2
    s_cmp_eq_u32 s68, 3
    s_cbranch_scc1 OB_CK3
    s_cmp_eq_u32 s68, 4
    s_cbranch_scc1 OB_CK4
    s_cmp_eq_u32 s68, 5
    s_cbranch_scc1 OB_CK5
    s_cmp_eq_u32 s68, 6
    s_cbranch_scc1 OB_CK6
    s_branch OB_CK7
K_LAST:
    s_endpgm
.section .rodata,"a"
.p2align 6
.amdhsa_kernel gated_mix__spectral_fnet__linear_kernel_hedgehog__prompt_kernel
  .amdhsa_next_free_vgpr 256
  .amdhsa_next_free_sgpr 102
  .amdhsa_accum_offset 256
  .amdhsa_group_segment_fixed_size 0
  .amdhsa_kernarg_size 104
  .amdhsa_user_sgpr_count 2
  .amdhsa_user_sgpr_kernarg_segment_ptr 1
  .amdhsa_system_sgpr_workgroup_id_x 1
.end_amdhsa_kernel
```
